```python
import torch

def _softmax(x, axis=-1):
    return torch.softmax(x, dim=axis)
def _gelu(x):
    return torch.nn.functional.gelu(x, approximate="tanh")
def _silu(x):
    return torch.nn.functional.silu(x)
def _sigmoid(x):
    return torch.sigmoid(x)
def _layernorm(x, axis=-1, eps=1e-5):
    m = x.mean(dim=axis, keepdim=True)
    v = x.var(dim=axis, keepdim=True, unbiased=False)
    return (x - m) / torch.sqrt(v + eps)
def _scatter_add(tgt, idx, src, axis=0):
    return tgt.clone().index_add_(axis, idx, src)
def _segment_sum(src, seg, n):
    out = torch.zeros((n,) + src.shape[1:], dtype=src.dtype)
    return out.index_add_(0, seg, src)
def _pad(x, pw):
    flat = tuple(v for pair in reversed(pw) for v in pair)
    return torch.nn.functional.pad(x, flat)

kernel_name = 'standalone__swiglu_ffn__prompt'

def setup_inputs():

    _w = (lambda a: (lambda t: t.to(torch.bfloat16) if t.is_floating_point() else t)(torch.as_tensor(a)))
    B, S, D, F = 1, 2048, 640, 1728
    return {
        "x": _w((lambda *s: torch.randn(*s, dtype=torch.bfloat16) * 0.05)(B, S, D)),
        "w_gate": _w((lambda *s: torch.randn(*s, dtype=torch.bfloat16) * 0.05)(D, F)),
        "w_up": _w((lambda *s: torch.randn(*s, dtype=torch.bfloat16) * 0.05)(D, F)),
        "w_down": _w((lambda *s: torch.randn(*s, dtype=torch.bfloat16) * 0.05)(F, D)),
    }

def reference(x, w_gate, w_up, w_down):
    g = _silu(x @ w_gate)
    u = x @ w_up
    return (g * u) @ w_down
```

```asm
; @launch grid=(256,1,1) block=(512,1,1) lds=163840
.amdgcn_target "amdgcn-amd-amdhsa--gfx950"
.text
.globl standalone__swiglu_ffn__prompt_kernel
.p2align 8
.type standalone__swiglu_ffn__prompt_kernel,@function
standalone__swiglu_ffn__prompt_kernel:
s_cmp_ge_u32 s2, 256
s_cbranch_scc1 standalone__swiglu_ffn__prompt_kernel_exit
s_load_dwordx4 s[4:7], s[0:1], 0
s_load_dwordx4 s[36:39], s[0:1], 16
s_load_dwordx4 s[40:43], s[0:1], 32
s_load_dwordx2 s[44:45], s[0:1], 48
v_lshrrev_b32 v1, 6, v0
v_and_b32 v0, 63, v0
v_readfirstlane_b32 s3, v1
v_lshlrev_b32 v10, 4, v0
s_and_b32 s46, s2, 7
s_lshr_b32 s47, s2, 3
s_and_b32 s48, s46, 1
s_lshl_b32 s48, s48, 2
s_and_b32 s52, s47, 3
s_add_u32 s48, s48, s52
s_lshr_b32 s49, s46, 1
s_mul_i32 s49, s49, 7
s_lshr_b32 s53, s47, 2
s_add_u32 s49, s49, s53
s_lshl_b32 s50, s46, 2
s_add_u32 s50, s50, s52
s_mov_b32 s51, s53
s_cmp_ge_u32 s53, 7
s_cselect_b32 s54, 1, 0
s_cmp_ge_u32 s49, 27
s_cselect_b32 s54, 1, s54
s_cmp_lt_u32 s3, 3
s_cselect_b32 s55, s54, 0
s_cmp_eq_u32 s55, 1
s_cbranch_scc1 standalone__swiglu_ffn__prompt_kernel_pf_entry
s_and_b32 s55, s3, 3
s_mov_b32 s10, 2621440
s_mov_b32 s11, 0x20000
s_mov_b32 s14, 2211840
s_mov_b32 s15, 0x20000
s_mov_b32 s18, 2211840
s_mov_b32 s19, 0x20000
s_cmp_lt_u32 s3, 4
s_cbranch_scc1 standalone__swiglu_ffn__prompt_kernel_cw
v_lshrrev_b32 v1, 3, v0
v_and_b32 v2, 7, v0
v_lshrrev_b32 v3, 1, v1
s_and_b32 s56, s55, 1
s_lshl_b32 s57, s56, 2
v_xor_b32 v4, v2, v3
v_xor_b32 v4, s57, v4
v_lshlrev_b32 v4, 4, v4
v_mul_u32_u24 v5, 1280, v1
v_add_u32 v4, v4, v5
v_and_b32 v5, 1, v3
s_lshl_b32 s57, s56, 1
v_or_b32 v5, s57, v5
v_lshrrev_b32 v6, 1, v2
v_xor_b32 v5, v5, v6
v_lshlrev_b32 v5, 5, v5
v_and_b32 v6, 1, v2
v_lshlrev_b32 v6, 4, v6
v_add_u32 v5, v5, v6
v_mul_u32_u24 v6, 3456, v1
v_add_u32 v5, v5, v6
s_lshl_b32 s57, s48, 8
s_lshl_b32 s58, s55, 3
s_add_u32 s57, s57, s58
s_mul_i32 s57, s57, 1280
s_mul_i32 s58, s58, 3456
s_lshl_b32 s59, s49, 7
s_add_u32 s58, s58, s59
s_lshl_b32 s59, s55, 10
s_waitcnt lgkmcnt(0)
s_mov_b32 s8, s4
s_mov_b32 s9, s5
s_mov_b32 s12, s6
s_mov_b32 s13, s7
s_mov_b32 s16, s36
s_mov_b32 s17, s37
s_cmp_eq_u32 s54, 1
s_cbranch_scc1 standalone__swiglu_ffn__prompt_kernel_spare_ld
s_add_u32 m0, s59, 0
s_add_u32 s61, s57, 0
buffer_load_dwordx4 v4, s[8:11], s61 offen  lds
s_add_u32 m0, s59, 4096
s_add_u32 s61, s57, 40960
buffer_load_dwordx4 v4, s[8:11], s61 offen  lds
s_add_u32 m0, s59, 98304
s_add_u32 s61, s58, 0
buffer_load_dwordx4 v5, s[12:15], s61 offen  lds
s_add_u32 m0, s59, 8192
s_add_u32 s61, s57, 81920
buffer_load_dwordx4 v4, s[8:11], s61 offen  lds
s_add_u32 m0, s59, 12288
s_add_u32 s61, s57, 122880
buffer_load_dwordx4 v4, s[8:11], s61 offen  lds
s_add_u32 m0, s59, 102400
s_add_u32 s61, s58, 110592
buffer_load_dwordx4 v5, s[12:15], s61 offen  lds
s_add_u32 m0, s59, 16384
s_add_u32 s61, s57, 163840
buffer_load_dwordx4 v4, s[8:11], s61 offen  lds
s_add_u32 m0, s59, 20480
s_add_u32 s61, s57, 204800
buffer_load_dwordx4 v4, s[8:11], s61 offen  lds
s_add_u32 m0, s59, 106496
s_add_u32 s61, s58, 0
buffer_load_dwordx4 v5, s[16:19], s61 offen  lds
s_add_u32 m0, s59, 24576
s_add_u32 s61, s57, 245760
buffer_load_dwordx4 v4, s[8:11], s61 offen  lds
s_add_u32 m0, s59, 28672
s_add_u32 s61, s57, 286720
buffer_load_dwordx4 v4, s[8:11], s61 offen  lds
s_add_u32 m0, s59, 110592
s_add_u32 s61, s58, 110592
buffer_load_dwordx4 v5, s[16:19], s61 offen  lds
s_add_u32 m0, s59, 32768
s_add_u32 s61, s57, 128
buffer_load_dwordx4 v4, s[8:11], s61 offen  lds
s_add_u32 m0, s59, 36864
s_add_u32 s61, s57, 41088
buffer_load_dwordx4 v4, s[8:11], s61 offen  lds
s_add_u32 m0, s59, 114688
s_add_u32 s61, s58, 221184
buffer_load_dwordx4 v5, s[12:15], s61 offen  lds
s_add_u32 m0, s59, 40960
s_add_u32 s61, s57, 82048
buffer_load_dwordx4 v4, s[8:11], s61 offen  lds
s_add_u32 m0, s59, 45056
s_add_u32 s61, s57, 123008
buffer_load_dwordx4 v4, s[8:11], s61 offen  lds
s_add_u32 m0, s59, 118784
s_add_u32 s61, s58, 331776
buffer_load_dwordx4 v5, s[12:15], s61 offen  lds
s_add_u32 m0, s59, 49152
s_add_u32 s61, s57, 163968
buffer_load_dwordx4 v4, s[8:11], s61 offen  lds
s_add_u32 m0, s59, 53248
s_add_u32 s61, s57, 204928
buffer_load_dwordx4 v4, s[8:11], s61 offen  lds
s_add_u32 m0, s59, 122880
s_add_u32 s61, s58, 221184
buffer_load_dwordx4 v5, s[16:19], s61 offen  lds
s_add_u32 m0, s59, 57344
s_add_u32 s61, s57, 245888
buffer_load_dwordx4 v4, s[8:11], s61 offen  lds
s_add_u32 m0, s59, 61440
s_add_u32 s61, s57, 286848
buffer_load_dwordx4 v4, s[8:11], s61 offen  lds
s_add_u32 m0, s59, 126976
s_add_u32 s61, s58, 331776
buffer_load_dwordx4 v5, s[16:19], s61 offen  lds
s_waitcnt vmcnt(12)
s_barrier
s_add_u32 m0, s59, 65536
s_add_u32 s61, s57, 256
buffer_load_dwordx4 v4, s[8:11], s61 offen  lds
s_add_u32 m0, s59, 69632
s_add_u32 s61, s57, 41216
buffer_load_dwordx4 v4, s[8:11], s61 offen  lds
s_add_u32 m0, s59, 131072
s_add_u32 s61, s58, 442368
buffer_load_dwordx4 v5, s[12:15], s61 offen  lds
s_add_u32 m0, s59, 73728
s_add_u32 s61, s57, 82176
buffer_load_dwordx4 v4, s[8:11], s61 offen  lds
s_add_u32 m0, s59, 77824
s_add_u32 s61, s57, 123136
buffer_load_dwordx4 v4, s[8:11], s61 offen  lds
s_add_u32 m0, s59, 135168
s_add_u32 s61, s58, 552960
buffer_load_dwordx4 v5, s[12:15], s61 offen  lds
s_add_u32 m0, s59, 81920
s_add_u32 s61, s57, 164096
buffer_load_dwordx4 v4, s[8:11], s61 offen  lds
s_add_u32 m0, s59, 86016
s_add_u32 s61, s57, 205056
buffer_load_dwordx4 v4, s[8:11], s61 offen  lds
s_add_u32 m0, s59, 139264
s_add_u32 s61, s58, 442368
buffer_load_dwordx4 v5, s[16:19], s61 offen  lds
s_add_u32 m0, s59, 90112
s_add_u32 s61, s57, 246016
buffer_load_dwordx4 v4, s[8:11], s61 offen  lds
s_add_u32 m0, s59, 94208
s_add_u32 s61, s57, 286976
buffer_load_dwordx4 v4, s[8:11], s61 offen  lds
s_add_u32 m0, s59, 143360
s_add_u32 s61, s58, 552960
buffer_load_dwordx4 v5, s[16:19], s61 offen  lds
s_waitcnt vmcnt(12)
s_barrier
s_add_u32 m0, s59, 0
s_add_u32 s61, s57, 384
buffer_load_dwordx4 v4, s[8:11], s61 offen  lds
s_add_u32 m0, s59, 4096
s_add_u32 s61, s57, 41344
buffer_load_dwordx4 v4, s[8:11], s61 offen  lds
s_add_u32 m0, s59, 98304
s_add_u32 s61, s58, 663552
buffer_load_dwordx4 v5, s[12:15], s61 offen  lds
s_add_u32 m0, s59, 8192
s_add_u32 s61, s57, 82304
buffer_load_dwordx4 v4, s[8:11], s61 offen  lds
s_add_u32 m0, s59, 12288
s_add_u32 s61, s57, 123264
buffer_load_dwordx4 v4, s[8:11], s61 offen  lds
s_add_u32 m0, s59, 102400
s_add_u32 s61, s58, 774144
buffer_load_dwordx4 v5, s[12:15], s61 offen  lds
s_add_u32 m0, s59, 16384
s_add_u32 s61, s57, 164224
buffer_load_dwordx4 v4, s[8:11], s61 offen  lds
s_add_u32 m0, s59, 20480
s_add_u32 s61, s57, 205184
buffer_load_dwordx4 v4, s[8:11], s61 offen  lds
s_add_u32 m0, s59, 106496
s_add_u32 s61, s58, 663552
buffer_load_dwordx4 v5, s[16:19], s61 offen  lds
s_add_u32 m0, s59, 24576
s_add_u32 s61, s57, 246144
buffer_load_dwordx4 v4, s[8:11], s61 offen  lds
s_add_u32 m0, s59, 28672
s_add_u32 s61, s57, 287104
buffer_load_dwordx4 v4, s[8:11], s61 offen  lds
s_add_u32 m0, s59, 110592
s_add_u32 s61, s58, 774144
buffer_load_dwordx4 v5, s[16:19], s61 offen  lds
s_waitcnt vmcnt(12)
s_barrier
s_add_u32 m0, s59, 32768
s_add_u32 s61, s57, 512
buffer_load_dwordx4 v4, s[8:11], s61 offen  lds
s_add_u32 m0, s59, 36864
s_add_u32 s61, s57, 41472
buffer_load_dwordx4 v4, s[8:11], s61 offen  lds
s_add_u32 m0, s59, 114688
s_add_u32 s61, s58, 884736
buffer_load_dwordx4 v5, s[12:15], s61 offen  lds
s_add_u32 m0, s59, 40960
s_add_u32 s61, s57, 82432
buffer_load_dwordx4 v4, s[8:11], s61 offen  lds
s_add_u32 m0, s59, 45056
s_add_u32 s61, s57, 123392
buffer_load_dwordx4 v4, s[8:11], s61 offen  lds
s_add_u32 m0, s59, 118784
s_add_u32 s61, s58, 995328
buffer_load_dwordx4 v5, s[12:15], s61 offen  lds
s_add_u32 m0, s59, 49152
s_add_u32 s61, s57, 164352
buffer_load_dwordx4 v4, s[8:11], s61 offen  lds
s_add_u32 m0, s59, 53248
s_add_u32 s61, s57, 205312
buffer_load_dwordx4 v4, s[8:11], s61 offen  lds
s_add_u32 m0, s59, 122880
s_add_u32 s61, s58, 884736
buffer_load_dwordx4 v5, s[16:19], s61 offen  lds
s_add_u32 m0, s59, 57344
s_add_u32 s61, s57, 246272
buffer_load_dwordx4 v4, s[8:11], s61 offen  lds
s_add_u32 m0, s59, 61440
s_add_u32 s61, s57, 287232
buffer_load_dwordx4 v4, s[8:11], s61 offen  lds
s_add_u32 m0, s59, 126976
s_add_u32 s61, s58, 995328
buffer_load_dwordx4 v5, s[16:19], s61 offen  lds
s_waitcnt vmcnt(12)
s_barrier
s_add_u32 m0, s59, 65536
s_add_u32 s61, s57, 640
buffer_load_dwordx4 v4, s[8:11], s61 offen  lds
s_add_u32 m0, s59, 69632
s_add_u32 s61, s57, 41600
buffer_load_dwordx4 v4, s[8:11], s61 offen  lds
s_add_u32 m0, s59, 131072
s_add_u32 s61, s58, 1105920
buffer_load_dwordx4 v5, s[12:15], s61 offen  lds
s_add_u32 m0, s59, 73728
s_add_u32 s61, s57, 82560
buffer_load_dwordx4 v4, s[8:11], s61 offen  lds
s_add_u32 m0, s59, 77824
s_add_u32 s61, s57, 123520
buffer_load_dwordx4 v4, s[8:11], s61 offen  lds
s_add_u32 m0, s59, 135168
s_add_u32 s61, s58, 1216512
buffer_load_dwordx4 v5, s[12:15], s61 offen  lds
s_add_u32 m0, s59, 81920
s_add_u32 s61, s57, 164480
buffer_load_dwordx4 v4, s[8:11], s61 offen  lds
s_add_u32 m0, s59, 86016
s_add_u32 s61, s57, 205440
buffer_load_dwordx4 v4, s[8:11], s61 offen  lds
s_add_u32 m0, s59, 139264
s_add_u32 s61, s58, 1105920
buffer_load_dwordx4 v5, s[16:19], s61 offen  lds
s_add_u32 m0, s59, 90112
s_add_u32 s61, s57, 246400
buffer_load_dwordx4 v4, s[8:11], s61 offen  lds
s_add_u32 m0, s59, 94208
s_add_u32 s61, s57, 287360
buffer_load_dwordx4 v4, s[8:11], s61 offen  lds
s_add_u32 m0, s59, 143360
s_add_u32 s61, s58, 1216512
buffer_load_dwordx4 v5, s[16:19], s61 offen  lds
s_waitcnt vmcnt(12)
s_barrier
s_add_u32 m0, s59, 0
s_add_u32 s61, s57, 768
buffer_load_dwordx4 v4, s[8:11], s61 offen  lds
s_add_u32 m0, s59, 4096
s_add_u32 s61, s57, 41728
buffer_load_dwordx4 v4, s[8:11], s61 offen  lds
s_add_u32 m0, s59, 98304
s_add_u32 s61, s58, 1327104
buffer_load_dwordx4 v5, s[12:15], s61 offen  lds
s_add_u32 m0, s59, 8192
s_add_u32 s61, s57, 82688
buffer_load_dwordx4 v4, s[8:11], s61 offen  lds
s_add_u32 m0, s59, 12288
s_add_u32 s61, s57, 123648
buffer_load_dwordx4 v4, s[8:11], s61 offen  lds
s_add_u32 m0, s59, 102400
s_add_u32 s61, s58, 1437696
buffer_load_dwordx4 v5, s[12:15], s61 offen  lds
s_add_u32 m0, s59, 16384
s_add_u32 s61, s57, 164608
buffer_load_dwordx4 v4, s[8:11], s61 offen  lds
s_add_u32 m0, s59, 20480
s_add_u32 s61, s57, 205568
buffer_load_dwordx4 v4, s[8:11], s61 offen  lds
s_add_u32 m0, s59, 106496
s_add_u32 s61, s58, 1327104
buffer_load_dwordx4 v5, s[16:19], s61 offen  lds
s_add_u32 m0, s59, 24576
s_add_u32 s61, s57, 246528
buffer_load_dwordx4 v4, s[8:11], s61 offen  lds
s_add_u32 m0, s59, 28672
s_add_u32 s61, s57, 287488
buffer_load_dwordx4 v4, s[8:11], s61 offen  lds
s_add_u32 m0, s59, 110592
s_add_u32 s61, s58, 1437696
buffer_load_dwordx4 v5, s[16:19], s61 offen  lds
s_mov_b32 s24, s38
s_mov_b32 s25, s39
s_mov_b32 s26, 2211840
s_mov_b32 s27, 0x20000
s_add_u32 s20, s44, 8388608
s_addc_u32 s21, s45, 0
s_mov_b32 s22, 2211840
s_mov_b32 s23, 0x20000
s_and_b32 s61, s55, 1
s_mul_i32 s61, s61, 27
s_lshr_b32 s64, s55, 1
s_add_u32 s67, s61, s64
s_mul_i32 s66, s51, 276480
s_mul_i32 s61, s67, 5120
s_add_u32 s66, s66, s61
s_mul_i32 s61, s67, 40960
s_mul_i32 s60, s51, 160
s_add_u32 s60, s60, s61
s_lshl_b32 s61, s2, 7
s_add_u32 s61, s61, 12582912
s_add_u32 s62, s44, s61
s_addc_u32 s63, s45, 0
v_mov_b32 v9, 112
s_waitcnt vmcnt(12)
s_barrier
s_add_u32 m0, s59, 32768
s_add_u32 s61, s57, 896
buffer_load_dwordx4 v4, s[8:11], s61 offen  lds
s_add_u32 m0, s59, 36864
s_add_u32 s61, s57, 41856
buffer_load_dwordx4 v4, s[8:11], s61 offen  lds
s_add_u32 m0, s59, 114688
s_add_u32 s61, s58, 1548288
buffer_load_dwordx4 v5, s[12:15], s61 offen  lds
s_add_u32 m0, s59, 40960
s_add_u32 s61, s57, 82816
buffer_load_dwordx4 v4, s[8:11], s61 offen  lds
s_add_u32 m0, s59, 45056
s_add_u32 s61, s57, 123776
buffer_load_dwordx4 v4, s[8:11], s61 offen  lds
s_add_u32 m0, s59, 118784
s_add_u32 s61, s58, 1658880
buffer_load_dwordx4 v5, s[12:15], s61 offen  lds
s_add_u32 m0, s59, 49152
s_add_u32 s61, s57, 164736
buffer_load_dwordx4 v4, s[8:11], s61 offen  lds
s_add_u32 m0, s59, 53248
s_add_u32 s61, s57, 205696
buffer_load_dwordx4 v4, s[8:11], s61 offen  lds
s_add_u32 m0, s59, 122880
s_add_u32 s61, s58, 1548288
buffer_load_dwordx4 v5, s[16:19], s61 offen  lds
s_add_u32 m0, s59, 57344
s_add_u32 s61, s57, 246656
buffer_load_dwordx4 v4, s[8:11], s61 offen  lds
s_add_u32 m0, s59, 61440
s_add_u32 s61, s57, 287616
buffer_load_dwordx4 v4, s[8:11], s61 offen  lds
s_add_u32 m0, s59, 126976
s_add_u32 s61, s58, 1658880
buffer_load_dwordx4 v5, s[16:19], s61 offen  lds
s_mov_b32 s28, 148480
s_cmp_eq_u32 s55, 1
s_cselect_b32 s28, 153600, s28
s_cmp_eq_u32 s55, 2
s_cselect_b32 s28, 35840, s28
s_cmp_eq_u32 s55, 3
s_cselect_b32 s28, 40960, s28
s_mov_b32 s29, 46080
s_cmp_eq_u32 s55, 1
s_cselect_b32 s29, 51200, s29
s_cmp_eq_u32 s55, 2
s_cselect_b32 s29, 56320, s29
s_cmp_eq_u32 s55, 3
s_cselect_b32 s29, 117760, s29
s_mov_b32 s30, 122880
s_cmp_eq_u32 s55, 1
s_cselect_b32 s30, 61440, s30
s_cmp_eq_u32 s55, 2
s_cselect_b32 s30, 66560, s30
s_cmp_eq_u32 s55, 3
s_cselect_b32 s30, 71680, s30
s_mul_i32 s31, s55, 5120
s_add_u32 s31, s31, 76800
s_mul_i32 s32, s55, 5120
s_add_u32 s32, s32, 128000
s_mul_i32 s33, s55, 5120
s_add_u32 s33, s33, 0
s_mov_b32 s34, 20480
s_cmp_eq_u32 s55, 1
s_cselect_b32 s34, 25600, s34
s_cmp_eq_u32 s55, 2
s_cselect_b32 s34, 30720, s34
s_cmp_eq_u32 s55, 3
s_cselect_b32 s34, 97280, s34
s_mov_b32 s35, 102400
s_cmp_eq_u32 s55, 1
s_cselect_b32 s35, 107520, s35
s_cmp_eq_u32 s55, 2
s_cselect_b32 s35, 112640, s35
s_cmp_eq_u32 s55, 3
s_cselect_b32 s35, 112640, s35
s_waitcnt vmcnt(12)
s_barrier
s_add_u32 m0, s59, 65536
s_add_u32 s61, s57, 1024
buffer_load_dwordx4 v4, s[8:11], s61 offen  lds
s_add_u32 m0, s59, 69632
s_add_u32 s61, s57, 41984
buffer_load_dwordx4 v4, s[8:11], s61 offen  lds
s_add_u32 m0, s59, 131072
s_add_u32 s61, s58, 1769472
buffer_load_dwordx4 v5, s[12:15], s61 offen  lds
s_add_u32 m0, s59, 73728
s_add_u32 s61, s57, 82944
buffer_load_dwordx4 v4, s[8:11], s61 offen  lds
s_add_u32 m0, s59, 77824
s_add_u32 s61, s57, 123904
buffer_load_dwordx4 v4, s[8:11], s61 offen  lds
s_add_u32 m0, s59, 135168
s_add_u32 s61, s58, 1880064
buffer_load_dwordx4 v5, s[12:15], s61 offen  lds
s_add_u32 m0, s59, 81920
s_add_u32 s61, s57, 164864
buffer_load_dwordx4 v4, s[8:11], s61 offen  lds
s_add_u32 m0, s59, 86016
s_add_u32 s61, s57, 205824
buffer_load_dwordx4 v4, s[8:11], s61 offen  lds
s_add_u32 m0, s59, 139264
s_add_u32 s61, s58, 1769472
buffer_load_dwordx4 v5, s[16:19], s61 offen  lds
s_add_u32 m0, s59, 90112
s_add_u32 s61, s57, 246784
buffer_load_dwordx4 v4, s[8:11], s61 offen  lds
s_add_u32 m0, s59, 94208
s_add_u32 s61, s57, 287744
buffer_load_dwordx4 v4, s[8:11], s61 offen  lds
s_add_u32 m0, s59, 143360
s_add_u32 s61, s58, 1880064
buffer_load_dwordx4 v5, s[16:19], s61 offen  lds
v_add_u32 v1, 0, v0
v_mul_u32_u24 v2, 6554, v1
v_lshrrev_b32 v2, 16, v2
v_mul_u32_u24 v3, 10, v2
v_sub_u32 v3, v1, v3
v_mul_u32_u24 v2, 1280, v2
v_lshlrev_b32 v3, 4, v3
v_add_u32 v136, v2, v3
v_add_u32 v1, 64, v0
v_mul_u32_u24 v2, 6554, v1
v_lshrrev_b32 v2, 16, v2
v_mul_u32_u24 v3, 10, v2
v_sub_u32 v3, v1, v3
v_mul_u32_u24 v2, 1280, v2
v_lshlrev_b32 v3, 4, v3
v_add_u32 v137, v2, v3
v_add_u32 v1, 128, v0
v_mul_u32_u24 v2, 6554, v1
v_lshrrev_b32 v2, 16, v2
v_mul_u32_u24 v3, 10, v2
v_sub_u32 v3, v1, v3
v_mul_u32_u24 v2, 1280, v2
v_lshlrev_b32 v3, 4, v3
v_add_u32 v138, v2, v3
v_add_u32 v1, 192, v0
v_mul_u32_u24 v2, 6554, v1
v_lshrrev_b32 v2, 16, v2
v_mul_u32_u24 v3, 10, v2
v_sub_u32 v3, v1, v3
v_mul_u32_u24 v2, 1280, v2
v_lshlrev_b32 v3, 4, v3
v_add_u32 v139, v2, v3
v_add_u32 v1, 256, v0
v_mul_u32_u24 v2, 6554, v1
v_lshrrev_b32 v2, 16, v2
v_mul_u32_u24 v3, 10, v2
v_sub_u32 v3, v1, v3
v_mul_u32_u24 v2, 1280, v2
v_lshlrev_b32 v3, 4, v3
v_add_u32 v140, v2, v3
s_waitcnt vmcnt(12)
s_barrier
s_add_u32 m0, s59, 0
s_add_u32 s61, s57, 1152
buffer_load_dwordx4 v4, s[8:11], s61 offen  lds
s_add_u32 m0, s59, 4096
s_add_u32 s61, s57, 42112
buffer_load_dwordx4 v4, s[8:11], s61 offen  lds
s_add_u32 m0, s59, 98304
s_add_u32 s61, s58, 1990656
buffer_load_dwordx4 v5, s[12:15], s61 offen  lds
s_add_u32 m0, s59, 8192
s_add_u32 s61, s57, 83072
buffer_load_dwordx4 v4, s[8:11], s61 offen  lds
s_add_u32 m0, s59, 12288
s_add_u32 s61, s57, 124032
buffer_load_dwordx4 v4, s[8:11], s61 offen  lds
s_add_u32 m0, s59, 102400
s_add_u32 s61, s58, 2101248
buffer_load_dwordx4 v5, s[12:15], s61 offen  lds
s_add_u32 m0, s59, 16384
s_add_u32 s61, s57, 164992
buffer_load_dwordx4 v4, s[8:11], s61 offen  lds
s_add_u32 m0, s59, 20480
s_add_u32 s61, s57, 205952
buffer_load_dwordx4 v4, s[8:11], s61 offen  lds
s_add_u32 m0, s59, 106496
s_add_u32 s61, s58, 1990656
buffer_load_dwordx4 v5, s[16:19], s61 offen  lds
s_add_u32 m0, s59, 24576
s_add_u32 s61, s57, 246912
buffer_load_dwordx4 v4, s[8:11], s61 offen  lds
s_add_u32 m0, s59, 28672
s_add_u32 s61, s57, 287872
buffer_load_dwordx4 v4, s[8:11], s61 offen  lds
s_add_u32 m0, s59, 110592
s_add_u32 s61, s58, 2101248
buffer_load_dwordx4 v5, s[16:19], s61 offen  lds
s_waitcnt vmcnt(12)
s_barrier
global_load_dword v8, v9, s[62:63] sc1
s_add_u32 m0, s28, 0
s_add_u32 s61, s60, 0
buffer_load_dwordx4 v136, s[24:27], s61 offen  lds
s_add_u32 m0, s28, 1024
s_add_u32 s61, s60, 0
buffer_load_dwordx4 v137, s[24:27], s61 offen  lds
s_add_u32 m0, s28, 2048
s_add_u32 s61, s60, 0
buffer_load_dwordx4 v138, s[24:27], s61 offen  lds
s_add_u32 m0, s28, 3072
s_add_u32 s61, s60, 0
buffer_load_dwordx4 v139, s[24:27], s61 offen  lds
s_add_u32 m0, s28, 4096
s_add_u32 s61, s60, 0
buffer_load_dwordx4 v140, s[24:27], s61 offen  lds
s_add_u32 m0, s29, 0
s_add_u32 s61, s60, 81920
buffer_load_dwordx4 v136, s[24:27], s61 offen  lds
s_add_u32 m0, s29, 1024
s_add_u32 s61, s60, 81920
buffer_load_dwordx4 v137, s[24:27], s61 offen  lds
s_add_u32 m0, s29, 2048
s_add_u32 s61, s60, 81920
buffer_load_dwordx4 v138, s[24:27], s61 offen  lds
s_add_u32 m0, s29, 3072
s_add_u32 s61, s60, 81920
buffer_load_dwordx4 v139, s[24:27], s61 offen  lds
s_add_u32 m0, s29, 4096
s_add_u32 s61, s60, 81920
buffer_load_dwordx4 v140, s[24:27], s61 offen  lds
s_waitcnt vmcnt(10)
s_barrier
v_readfirstlane_b32 s64, v8
s_cmp_eq_u32 s64, 1
s_cbranch_scc0 standalone__swiglu_ffn__prompt_kernel_late
s_add_u32 m0, s30, 0
s_add_u32 s61, s66, 20480
buffer_load_dwordx4 v10, s[20:23], s61 offen sc1 lds
s_add_u32 m0, s30, 1024
s_add_u32 s61, s66, 21504
buffer_load_dwordx4 v10, s[20:23], s61 offen sc1 lds
s_add_u32 m0, s30, 2048
s_add_u32 s61, s66, 22528
buffer_load_dwordx4 v10, s[20:23], s61 offen sc1 lds
s_add_u32 m0, s30, 3072
s_add_u32 s61, s66, 23552
buffer_load_dwordx4 v10, s[20:23], s61 offen sc1 lds
s_add_u32 m0, s30, 4096
s_add_u32 s61, s66, 24576
buffer_load_dwordx4 v10, s[20:23], s61 offen sc1 lds
s_add_u32 m0, s31, 0
s_add_u32 s61, s66, 30720
buffer_load_dwordx4 v10, s[20:23], s61 offen sc1 lds
s_add_u32 m0, s31, 1024
s_add_u32 s61, s66, 31744
buffer_load_dwordx4 v10, s[20:23], s61 offen sc1 lds
s_add_u32 m0, s31, 2048
s_add_u32 s61, s66, 32768
buffer_load_dwordx4 v10, s[20:23], s61 offen sc1 lds
s_add_u32 m0, s31, 3072
s_add_u32 s61, s66, 33792
buffer_load_dwordx4 v10, s[20:23], s61 offen sc1 lds
s_add_u32 m0, s31, 4096
s_add_u32 s61, s66, 34816
buffer_load_dwordx4 v10, s[20:23], s61 offen sc1 lds
s_barrier
s_branch standalone__swiglu_ffn__prompt_kernel_merge
standalone__swiglu_ffn__prompt_kernel_late:
global_load_dword v8, v9, s[62:63] sc1
s_barrier
s_waitcnt vmcnt(0)
v_readfirstlane_b32 s64, v8
s_cmp_eq_u32 s64, 1
s_cbranch_scc1 standalone__swiglu_ffn__prompt_kernel_late_ok
s_mov_b32 s65, 400000
standalone__swiglu_ffn__prompt_kernel_late_poll:
global_load_dword v8, v9, s[62:63] sc1
s_waitcnt vmcnt(0)
v_readfirstlane_b32 s64, v8
s_cmp_eq_u32 s64, 1
s_cbranch_scc1 standalone__swiglu_ffn__prompt_kernel_late_done
s_sub_u32 s65, s65, 1
s_cmp_lg_u32 s65, 0
s_cbranch_scc1 standalone__swiglu_ffn__prompt_kernel_late_poll
standalone__swiglu_ffn__prompt_kernel_late_done:
standalone__swiglu_ffn__prompt_kernel_late_ok:
s_add_u32 m0, s30, 0
s_add_u32 s61, s66, 20480
buffer_load_dwordx4 v10, s[20:23], s61 offen sc1 lds
s_add_u32 m0, s30, 1024
s_add_u32 s61, s66, 21504
buffer_load_dwordx4 v10, s[20:23], s61 offen sc1 lds
s_add_u32 m0, s30, 2048
s_add_u32 s61, s66, 22528
buffer_load_dwordx4 v10, s[20:23], s61 offen sc1 lds
s_add_u32 m0, s30, 3072
s_add_u32 s61, s66, 23552
buffer_load_dwordx4 v10, s[20:23], s61 offen sc1 lds
s_add_u32 m0, s30, 4096
s_add_u32 s61, s66, 24576
buffer_load_dwordx4 v10, s[20:23], s61 offen sc1 lds
s_add_u32 m0, s31, 0
s_add_u32 s61, s66, 30720
buffer_load_dwordx4 v10, s[20:23], s61 offen sc1 lds
s_add_u32 m0, s31, 1024
s_add_u32 s61, s66, 31744
buffer_load_dwordx4 v10, s[20:23], s61 offen sc1 lds
s_add_u32 m0, s31, 2048
s_add_u32 s61, s66, 32768
buffer_load_dwordx4 v10, s[20:23], s61 offen sc1 lds
s_add_u32 m0, s31, 3072
s_add_u32 s61, s66, 33792
buffer_load_dwordx4 v10, s[20:23], s61 offen sc1 lds
s_add_u32 m0, s31, 4096
s_add_u32 s61, s66, 34816
buffer_load_dwordx4 v10, s[20:23], s61 offen sc1 lds
standalone__swiglu_ffn__prompt_kernel_merge:
s_add_u32 m0, s32, 0
s_add_u32 s61, s66, 40960
buffer_load_dwordx4 v10, s[20:23], s61 offen sc1 lds
s_add_u32 m0, s32, 1024
s_add_u32 s61, s66, 41984
buffer_load_dwordx4 v10, s[20:23], s61 offen sc1 lds
s_add_u32 m0, s32, 2048
s_add_u32 s61, s66, 43008
buffer_load_dwordx4 v10, s[20:23], s61 offen sc1 lds
s_add_u32 m0, s32, 3072
s_add_u32 s61, s66, 44032
buffer_load_dwordx4 v10, s[20:23], s61 offen sc1 lds
s_add_u32 m0, s32, 4096
s_add_u32 s61, s66, 45056
buffer_load_dwordx4 v10, s[20:23], s61 offen sc1 lds
s_add_u32 m0, s33, 0
s_add_u32 s61, s66, 51200
buffer_load_dwordx4 v10, s[20:23], s61 offen sc1 lds
s_add_u32 m0, s33, 1024
s_add_u32 s61, s66, 52224
buffer_load_dwordx4 v10, s[20:23], s61 offen sc1 lds
s_add_u32 m0, s33, 2048
s_add_u32 s61, s66, 53248
buffer_load_dwordx4 v10, s[20:23], s61 offen sc1 lds
s_add_u32 m0, s33, 3072
s_add_u32 s61, s66, 54272
buffer_load_dwordx4 v10, s[20:23], s61 offen sc1 lds
s_add_u32 m0, s33, 4096
s_add_u32 s61, s66, 55296
buffer_load_dwordx4 v10, s[20:23], s61 offen sc1 lds
s_add_u32 m0, s34, 0
s_add_u32 s61, s66, 61440
buffer_load_dwordx4 v10, s[20:23], s61 offen sc1 lds
s_add_u32 m0, s34, 1024
s_add_u32 s61, s66, 62464
buffer_load_dwordx4 v10, s[20:23], s61 offen sc1 lds
s_add_u32 m0, s34, 2048
s_add_u32 s61, s66, 63488
buffer_load_dwordx4 v10, s[20:23], s61 offen sc1 lds
s_add_u32 m0, s34, 3072
s_add_u32 s61, s66, 64512
buffer_load_dwordx4 v10, s[20:23], s61 offen sc1 lds
s_add_u32 m0, s34, 4096
s_add_u32 s61, s66, 65536
buffer_load_dwordx4 v10, s[20:23], s61 offen sc1 lds
s_add_u32 s61, s66, 71680
buffer_load_dwordx4 v[16:19], v10, s[20:23], s61 offen sc1
s_add_u32 s61, s66, 72704
buffer_load_dwordx4 v[20:23], v10, s[20:23], s61 offen sc1
s_add_u32 s61, s66, 73728
buffer_load_dwordx4 v[24:27], v10, s[20:23], s61 offen sc1
s_add_u32 s61, s66, 74752
buffer_load_dwordx4 v[28:31], v10, s[20:23], s61 offen sc1
s_add_u32 s61, s66, 75776
buffer_load_dwordx4 v[32:35], v10, s[20:23], s61 offen sc1
s_add_u32 s61, s66, 81920
buffer_load_dwordx4 v[36:39], v10, s[20:23], s61 offen sc1
s_add_u32 s61, s66, 82944
buffer_load_dwordx4 v[40:43], v10, s[20:23], s61 offen sc1
s_add_u32 s61, s66, 83968
buffer_load_dwordx4 v[44:47], v10, s[20:23], s61 offen sc1
s_add_u32 s61, s66, 84992
buffer_load_dwordx4 v[48:51], v10, s[20:23], s61 offen sc1
s_add_u32 s61, s66, 86016
buffer_load_dwordx4 v[52:55], v10, s[20:23], s61 offen sc1
s_waitcnt vmcnt(20)
s_barrier
s_add_u32 s61, s66, 92160
buffer_load_dwordx4 v[56:59], v10, s[20:23], s61 offen sc1
s_add_u32 s61, s66, 93184
buffer_load_dwordx4 v[60:63], v10, s[20:23], s61 offen sc1
s_add_u32 s61, s66, 94208
buffer_load_dwordx4 v[64:67], v10, s[20:23], s61 offen sc1
s_add_u32 s61, s66, 95232
buffer_load_dwordx4 v[68:71], v10, s[20:23], s61 offen sc1
s_add_u32 s61, s66, 96256
buffer_load_dwordx4 v[72:75], v10, s[20:23], s61 offen sc1
s_add_u32 s61, s66, 102400
buffer_load_dwordx4 v[76:79], v10, s[20:23], s61 offen sc1
s_add_u32 s61, s66, 103424
buffer_load_dwordx4 v[80:83], v10, s[20:23], s61 offen sc1
s_add_u32 s61, s66, 104448
buffer_load_dwordx4 v[84:87], v10, s[20:23], s61 offen sc1
s_add_u32 s61, s66, 105472
buffer_load_dwordx4 v[88:91], v10, s[20:23], s61 offen sc1
s_add_u32 s61, s66, 106496
buffer_load_dwordx4 v[92:95], v10, s[20:23], s61 offen sc1
s_add_u32 m0, s35, 0
s_add_u32 s61, s66, 133120
buffer_load_dwordx4 v10, s[20:23], s61 offen sc1 lds
s_add_u32 m0, s35, 1024
s_add_u32 s61, s66, 134144
buffer_load_dwordx4 v10, s[20:23], s61 offen sc1 lds
s_add_u32 m0, s35, 2048
s_add_u32 s61, s66, 135168
buffer_load_dwordx4 v10, s[20:23], s61 offen sc1 lds
s_add_u32 m0, s35, 3072
s_add_u32 s61, s66, 136192
buffer_load_dwordx4 v10, s[20:23], s61 offen sc1 lds
s_add_u32 m0, s35, 4096
s_add_u32 s61, s66, 137216
buffer_load_dwordx4 v10, s[20:23], s61 offen sc1 lds
s_add_u32 s61, s66, 112640
buffer_load_dwordx4 v[96:99], v10, s[20:23], s61 offen sc1
s_add_u32 s61, s66, 113664
buffer_load_dwordx4 v[100:103], v10, s[20:23], s61 offen sc1
s_add_u32 s61, s66, 114688
buffer_load_dwordx4 v[104:107], v10, s[20:23], s61 offen sc1
s_add_u32 s61, s66, 115712
buffer_load_dwordx4 v[108:111], v10, s[20:23], s61 offen sc1
s_add_u32 s61, s66, 116736
buffer_load_dwordx4 v[112:115], v10, s[20:23], s61 offen sc1
s_add_u32 s61, s66, 122880
buffer_load_dwordx4 v[116:119], v10, s[20:23], s61 offen sc1
s_add_u32 s61, s66, 123904
buffer_load_dwordx4 v[120:123], v10, s[20:23], s61 offen sc1
s_add_u32 s61, s66, 124928
buffer_load_dwordx4 v[124:127], v10, s[20:23], s61 offen sc1
s_add_u32 s61, s66, 125952
buffer_load_dwordx4 v[128:131], v10, s[20:23], s61 offen sc1
s_add_u32 s61, s66, 126976
buffer_load_dwordx4 v[132:135], v10, s[20:23], s61 offen sc1
v_mov_b32 v12, 163584
s_mov_b32 s65, 400000
standalone__swiglu_ffn__prompt_kernel_yn_poll:
ds_read_b32 v13, v12 offset:16
s_waitcnt lgkmcnt(0)
v_readfirstlane_b32 s64, v13
s_cmp_ge_u32 s64, 4
s_cbranch_scc1 standalone__swiglu_ffn__prompt_kernel_yn_done
s_sub_u32 s65, s65, 1
s_cmp_lg_u32 s65, 0
s_cbranch_scc1 standalone__swiglu_ffn__prompt_kernel_yn_poll
standalone__swiglu_ffn__prompt_kernel_yn_done:
s_waitcnt vmcnt(25)
v_add_u32 v12, s28, v10
ds_write_b128 v12, v[16:19] offset:0
ds_write_b128 v12, v[20:23] offset:1024
ds_write_b128 v12, v[24:27] offset:2048
ds_write_b128 v12, v[28:31] offset:3072
ds_write_b128 v12, v[32:35] offset:4096
v_add_u32 v12, s29, v10
ds_write_b128 v12, v[36:39] offset:0
ds_write_b128 v12, v[40:43] offset:1024
ds_write_b128 v12, v[44:47] offset:2048
ds_write_b128 v12, v[48:51] offset:3072
ds_write_b128 v12, v[52:55] offset:4096
s_waitcnt vmcnt(35) lgkmcnt(0)
s_barrier
s_waitcnt vmcnt(15)
v_add_u32 v12, s30, v10
ds_write_b128 v12, v[56:59] offset:0
ds_write_b128 v12, v[60:63] offset:1024
ds_write_b128 v12, v[64:67] offset:2048
ds_write_b128 v12, v[68:71] offset:3072
ds_write_b128 v12, v[72:75] offset:4096
v_add_u32 v12, s31, v10
ds_write_b128 v12, v[76:79] offset:0
ds_write_b128 v12, v[80:83] offset:1024
ds_write_b128 v12, v[84:87] offset:2048
ds_write_b128 v12, v[88:91] offset:3072
ds_write_b128 v12, v[92:95] offset:4096
s_waitcnt vmcnt(0) lgkmcnt(0)
s_barrier
s_waitcnt vmcnt(0)
v_add_u32 v12, s32, v10
ds_write_b128 v12, v[96:99] offset:0
ds_write_b128 v12, v[100:103] offset:1024
ds_write_b128 v12, v[104:107] offset:2048
ds_write_b128 v12, v[108:111] offset:3072
ds_write_b128 v12, v[112:115] offset:4096
v_add_u32 v12, s33, v10
ds_write_b128 v12, v[116:119] offset:0
ds_write_b128 v12, v[120:123] offset:1024
ds_write_b128 v12, v[124:127] offset:2048
ds_write_b128 v12, v[128:131] offset:3072
ds_write_b128 v12, v[132:135] offset:4096
s_waitcnt lgkmcnt(0)
s_barrier
s_barrier
s_endpgm
standalone__swiglu_ffn__prompt_kernel_spare_ld:
s_sub_u32 s61, s47, 28
s_lshl_b32 s61, s61, 3
s_add_u32 s61, s61, s46
s_sub_u32 s60, s47, 24
s_lshl_b32 s60, s60, 1
s_add_u32 s60, s60, s46
s_add_u32 s60, s60, 26
s_cmp_ge_u32 s47, 28
s_cselect_b32 s69, s61, s60
s_barrier
s_cmp_ge_u32 s69, 36
s_cbranch_scc1 standalone__swiglu_ffn__prompt_kernel_rp_skip
s_mov_b32 s32, s38
s_mov_b32 s33, s39
s_mov_b32 s34, 2211840
s_mov_b32 s35, 0x20000
s_add_u32 s24, s44, 8388608
s_addc_u32 s25, s45, 0
s_mov_b32 s26, 2211840
s_mov_b32 s27, 0x20000
v_add_u32 v1, 0, v0
v_mul_u32_u24 v2, 1639, v1
v_lshrrev_b32 v2, 16, v2
v_mul_u32_u24 v3, 40, v2
v_sub_u32 v3, v1, v3
v_lshrrev_b32 v1, 1, v2
v_and_b32 v1, 3, v1
v_lshlrev_b32 v1, 1, v1
v_xor_b32 v3, v3, v1
v_mul_u32_u24 v2, 1280, v2
v_lshlrev_b32 v3, 4, v3
v_add_u32 v24, v2, v3
v_add_u32 v1, 64, v0
v_mul_u32_u24 v2, 1639, v1
v_lshrrev_b32 v2, 16, v2
v_mul_u32_u24 v3, 40, v2
v_sub_u32 v3, v1, v3
v_lshrrev_b32 v1, 1, v2
v_and_b32 v1, 3, v1
v_lshlrev_b32 v1, 1, v1
v_xor_b32 v3, v3, v1
v_mul_u32_u24 v2, 1280, v2
v_lshlrev_b32 v3, 4, v3
v_add_u32 v25, v2, v3
v_add_u32 v1, 128, v0
v_mul_u32_u24 v2, 1639, v1
v_lshrrev_b32 v2, 16, v2
v_mul_u32_u24 v3, 40, v2
v_sub_u32 v3, v1, v3
v_lshrrev_b32 v1, 1, v2
v_and_b32 v1, 3, v1
v_lshlrev_b32 v1, 1, v1
v_xor_b32 v3, v3, v1
v_mul_u32_u24 v2, 1280, v2
v_lshlrev_b32 v3, 4, v3
v_add_u32 v26, v2, v3
v_add_u32 v1, 192, v0
v_mul_u32_u24 v2, 1639, v1
v_lshrrev_b32 v2, 16, v2
v_mul_u32_u24 v3, 40, v2
v_sub_u32 v3, v1, v3
v_lshrrev_b32 v1, 1, v2
v_and_b32 v1, 3, v1
v_lshlrev_b32 v1, 1, v1
v_xor_b32 v3, v3, v1
v_mul_u32_u24 v2, 1280, v2
v_lshlrev_b32 v3, 4, v3
v_add_u32 v27, v2, v3
v_add_u32 v1, 256, v0
v_mul_u32_u24 v2, 1639, v1
v_lshrrev_b32 v2, 16, v2
v_mul_u32_u24 v3, 40, v2
v_sub_u32 v3, v1, v3
v_lshrrev_b32 v1, 1, v2
v_and_b32 v1, 3, v1
v_lshlrev_b32 v1, 1, v1
v_xor_b32 v3, v3, v1
v_mul_u32_u24 v2, 1280, v2
v_lshlrev_b32 v3, 4, v3
v_add_u32 v28, v2, v3
v_and_b32 v1, 3, v0
v_lshrrev_b32 v2, 2, v0
v_and_b32 v2, 3, v2
v_lshrrev_b32 v3, 4, v0
v_lshlrev_b32 v6, 2, v3
v_add_u32 v6, v6, v2
v_lshrrev_b32 v7, 1, v6
v_and_b32 v7, 3, v7
v_lshlrev_b32 v7, 1, v7
v_mul_u32_u24 v6, 640, v6
v_and_b32 v8, 1, v1
v_lshlrev_b32 v8, 3, v8
v_add_u32 v6, v6, v8
v_lshrrev_b32 v1, 1, v1
s_mul_i32 s65, s55, 10
s_add_u32 s65, s65, 0
v_add_u32 v8, s65, v1
v_xor_b32 v8, v8, v7
v_lshlrev_b32 v8, 4, v8
v_add_u32 v30, v6, v8
s_mul_i32 s65, s55, 10
s_add_u32 s65, s65, 2
v_add_u32 v8, s65, v1
v_xor_b32 v8, v8, v7
v_lshlrev_b32 v8, 4, v8
v_add_u32 v31, v6, v8
s_mul_i32 s65, s55, 10
s_add_u32 s65, s65, 4
v_add_u32 v8, s65, v1
v_xor_b32 v8, v8, v7
v_lshlrev_b32 v8, 4, v8
v_add_u32 v32, v6, v8
s_mul_i32 s65, s55, 10
s_add_u32 s65, s65, 6
v_add_u32 v8, s65, v1
v_xor_b32 v8, v8, v7
v_lshlrev_b32 v8, 4, v8
v_add_u32 v33, v6, v8
s_mul_i32 s65, s55, 10
s_add_u32 s65, s65, 8
v_add_u32 v8, s65, v1
v_xor_b32 v8, v8, v7
v_lshlrev_b32 v8, 4, v8
v_add_u32 v34, v6, v8
s_mul_i32 s60, s69, 3
s_add_u32 s60, s60, 0
s_lshr_b32 s61, s60, 1
s_and_b32 s60, s60, 1
s_mul_i32 s64, s61, 40960
s_mul_i32 s65, s55, 10240
s_add_u32 s64, s64, s65
s_mul_i32 s65, s60, 640
s_add_u32 s64, s64, s65
s_lshl_b32 s65, s60, 2
s_add_u32 s65, s65, s55
s_mul_i32 s65, s65, 54
s_add_u32 s65, s65, s61
s_mul_i32 s8, s65, 5120
s_mul_i32 s65, s55, 5120
s_add_u32 m0, s65, 0
s_nop 0
buffer_load_dwordx4 v24, s[32:35], s64 offen lds
s_add_u32 m0, s65, 1024
s_nop 0
buffer_load_dwordx4 v25, s[32:35], s64 offen lds
s_add_u32 m0, s65, 2048
s_nop 0
buffer_load_dwordx4 v26, s[32:35], s64 offen lds
s_add_u32 m0, s65, 3072
s_nop 0
buffer_load_dwordx4 v27, s[32:35], s64 offen lds
s_add_u32 m0, s65, 4096
s_nop 0
buffer_load_dwordx4 v28, s[32:35], s64 offen lds
s_mul_i32 s60, s69, 3
s_add_u32 s60, s60, 1
s_lshr_b32 s61, s60, 1
s_and_b32 s60, s60, 1
s_mul_i32 s64, s61, 40960
s_mul_i32 s65, s55, 10240
s_add_u32 s64, s64, s65
s_mul_i32 s65, s60, 640
s_add_u32 s64, s64, s65
s_lshl_b32 s65, s60, 2
s_add_u32 s65, s65, s55
s_mul_i32 s65, s65, 54
s_add_u32 s65, s65, s61
s_mul_i32 s9, s65, 5120
s_mul_i32 s65, s55, 5120
s_add_u32 m0, s65, 20480
s_nop 0
buffer_load_dwordx4 v24, s[32:35], s64 offen lds
s_add_u32 m0, s65, 21504
s_nop 0
buffer_load_dwordx4 v25, s[32:35], s64 offen lds
s_add_u32 m0, s65, 22528
s_nop 0
buffer_load_dwordx4 v26, s[32:35], s64 offen lds
s_add_u32 m0, s65, 23552
s_nop 0
buffer_load_dwordx4 v27, s[32:35], s64 offen lds
s_add_u32 m0, s65, 24576
s_nop 0
buffer_load_dwordx4 v28, s[32:35], s64 offen lds
s_mul_i32 s60, s69, 3
s_add_u32 s60, s60, 2
s_lshr_b32 s61, s60, 1
s_and_b32 s60, s60, 1
s_mul_i32 s64, s61, 40960
s_mul_i32 s65, s55, 10240
s_add_u32 s64, s64, s65
s_mul_i32 s65, s60, 640
s_add_u32 s64, s64, s65
s_lshl_b32 s65, s60, 2
s_add_u32 s65, s65, s55
s_mul_i32 s65, s65, 54
s_add_u32 s65, s65, s61
s_mul_i32 s10, s65, 5120
s_mul_i32 s65, s55, 5120
s_add_u32 m0, s65, 40960
s_nop 0
buffer_load_dwordx4 v24, s[32:35], s64 offen lds
s_add_u32 m0, s65, 41984
s_nop 0
buffer_load_dwordx4 v25, s[32:35], s64 offen lds
s_add_u32 m0, s65, 43008
s_nop 0
buffer_load_dwordx4 v26, s[32:35], s64 offen lds
s_add_u32 m0, s65, 44032
s_nop 0
buffer_load_dwordx4 v27, s[32:35], s64 offen lds
s_add_u32 m0, s65, 45056
s_nop 0
buffer_load_dwordx4 v28, s[32:35], s64 offen lds
s_waitcnt vmcnt(0)
v_mov_b32 v12, 163584
v_mov_b32 v11, 1
s_mov_b64 exec, 1
ds_add_u32 v12, v11 offset:8
s_mov_b64 exec, -1
s_mov_b32 s65, 400000
standalone__swiglu_ffn__prompt_kernel_rpl_poll:
ds_read_b32 v13, v12 offset:8
s_waitcnt lgkmcnt(0)
v_readfirstlane_b32 s64, v13
s_cmp_ge_u32 s64, 4
s_cbranch_scc1 standalone__swiglu_ffn__prompt_kernel_rpl_done
s_sub_u32 s65, s65, 1
s_cmp_lg_u32 s65, 0
s_cbranch_scc1 standalone__swiglu_ffn__prompt_kernel_rpl_poll
standalone__swiglu_ffn__prompt_kernel_rpl_done:
ds_read_b64_tr_b16 v[40:41], v30 offset:0
ds_read_b64_tr_b16 v[42:43], v30 offset:10240
ds_read_b64_tr_b16 v[44:45], v31 offset:0
ds_read_b64_tr_b16 v[46:47], v31 offset:10240
ds_read_b64_tr_b16 v[48:49], v32 offset:0
ds_read_b64_tr_b16 v[50:51], v32 offset:10240
ds_read_b64_tr_b16 v[52:53], v33 offset:0
ds_read_b64_tr_b16 v[54:55], v33 offset:10240
ds_read_b64_tr_b16 v[56:57], v34 offset:0
ds_read_b64_tr_b16 v[58:59], v34 offset:10240
ds_read_b64_tr_b16 v[60:61], v30 offset:20480
ds_read_b64_tr_b16 v[62:63], v30 offset:30720
ds_read_b64_tr_b16 v[64:65], v31 offset:20480
ds_read_b64_tr_b16 v[66:67], v31 offset:30720
ds_read_b64_tr_b16 v[68:69], v32 offset:20480
ds_read_b64_tr_b16 v[70:71], v32 offset:30720
ds_read_b64_tr_b16 v[72:73], v33 offset:20480
ds_read_b64_tr_b16 v[74:75], v33 offset:30720
ds_read_b64_tr_b16 v[76:77], v34 offset:20480
ds_read_b64_tr_b16 v[78:79], v34 offset:30720
ds_read_b64_tr_b16 v[80:81], v30 offset:40960
ds_read_b64_tr_b16 v[82:83], v30 offset:51200
ds_read_b64_tr_b16 v[84:85], v31 offset:40960
ds_read_b64_tr_b16 v[86:87], v31 offset:51200
ds_read_b64_tr_b16 v[88:89], v32 offset:40960
ds_read_b64_tr_b16 v[90:91], v32 offset:51200
ds_read_b64_tr_b16 v[92:93], v33 offset:40960
ds_read_b64_tr_b16 v[94:95], v33 offset:51200
ds_read_b64_tr_b16 v[96:97], v34 offset:40960
ds_read_b64_tr_b16 v[98:99], v34 offset:51200
s_waitcnt lgkmcnt(15)
s_add_u32 s65, s8, 0
buffer_store_dwordx4 v[40:43], v10, s[24:27], s65 offen sc1
s_waitcnt lgkmcnt(15)
s_add_u32 s65, s8, 1024
buffer_store_dwordx4 v[44:47], v10, s[24:27], s65 offen sc1
s_waitcnt lgkmcnt(15)
s_add_u32 s65, s8, 2048
buffer_store_dwordx4 v[48:51], v10, s[24:27], s65 offen sc1
s_waitcnt lgkmcnt(15)
s_add_u32 s65, s8, 3072
buffer_store_dwordx4 v[52:55], v10, s[24:27], s65 offen sc1
s_waitcnt lgkmcnt(15)
s_add_u32 s65, s8, 4096
buffer_store_dwordx4 v[56:59], v10, s[24:27], s65 offen sc1
s_waitcnt lgkmcnt(15)
s_add_u32 s65, s9, 0
buffer_store_dwordx4 v[60:63], v10, s[24:27], s65 offen sc1
s_waitcnt lgkmcnt(15)
s_add_u32 s65, s9, 1024
buffer_store_dwordx4 v[64:67], v10, s[24:27], s65 offen sc1
s_waitcnt lgkmcnt(14)
s_add_u32 s65, s9, 2048
buffer_store_dwordx4 v[68:71], v10, s[24:27], s65 offen sc1
s_waitcnt lgkmcnt(12)
s_add_u32 s65, s9, 3072
buffer_store_dwordx4 v[72:75], v10, s[24:27], s65 offen sc1
s_waitcnt lgkmcnt(10)
s_add_u32 s65, s9, 4096
buffer_store_dwordx4 v[76:79], v10, s[24:27], s65 offen sc1
s_waitcnt lgkmcnt(8)
s_add_u32 s65, s10, 0
buffer_store_dwordx4 v[80:83], v10, s[24:27], s65 offen sc1
s_waitcnt lgkmcnt(6)
s_add_u32 s65, s10, 1024
buffer_store_dwordx4 v[84:87], v10, s[24:27], s65 offen sc1
s_waitcnt lgkmcnt(4)
s_add_u32 s65, s10, 2048
buffer_store_dwordx4 v[88:91], v10, s[24:27], s65 offen sc1
s_waitcnt lgkmcnt(2)
s_add_u32 s65, s10, 3072
buffer_store_dwordx4 v[92:95], v10, s[24:27], s65 offen sc1
s_waitcnt lgkmcnt(0)
s_add_u32 s65, s10, 4096
buffer_store_dwordx4 v[96:99], v10, s[24:27], s65 offen sc1
v_mov_b32 v12, 163584
v_mov_b32 v11, 1
s_mov_b64 exec, 1
ds_add_u32 v12, v11 offset:40
s_mov_b64 exec, -1
s_waitcnt vmcnt(0)
v_mov_b32 v12, 163584
v_mov_b32 v11, 1
s_mov_b64 exec, 1
ds_add_rtn_u32 v13, v12, v11 offset:12
s_waitcnt lgkmcnt(0)
v_readfirstlane_b32 s64, v13
s_mov_b64 exec, -1
s_cmp_lg_u32 s64, 3
s_cbranch_scc1 standalone__swiglu_ffn__prompt_kernel_rp_done
v_mov_b32 v20, 0
v_mov_b32 v21, 1
s_mov_b64 exec, 1
global_atomic_add v20, v21, s[42:43] sc1
s_mov_b64 exec, -1
s_branch standalone__swiglu_ffn__prompt_kernel_rp_done
standalone__swiglu_ffn__prompt_kernel_rp_skip:
v_mov_b32 v12, 163584
v_mov_b32 v11, 1
s_mov_b64 exec, 1
ds_add_u32 v12, v11 offset:40
s_mov_b64 exec, -1
standalone__swiglu_ffn__prompt_kernel_rp_done:
s_barrier
s_mov_b32 s24, s38
s_mov_b32 s25, s39
s_mov_b32 s26, 2211840
s_mov_b32 s27, 0x20000
s_add_u32 s20, s44, 8388608
s_addc_u32 s21, s45, 0
s_mov_b32 s22, 2211840
s_mov_b32 s23, 0x20000
s_and_b32 s61, s55, 1
s_mul_i32 s61, s61, 27
s_lshr_b32 s64, s55, 1
s_add_u32 s67, s61, s64
s_mul_i32 s66, s51, 276480
s_mul_i32 s61, s67, 5120
s_add_u32 s66, s66, s61
s_mul_i32 s61, s67, 40960
s_mul_i32 s60, s51, 160
s_add_u32 s60, s60, s61
s_lshl_b32 s61, s2, 7
s_add_u32 s61, s61, 12582912
s_add_u32 s62, s44, s61
s_addc_u32 s63, s45, 0
v_mov_b32 v9, 112
s_mov_b32 s28, 148480
s_cmp_eq_u32 s55, 1
s_cselect_b32 s28, 153600, s28
s_cmp_eq_u32 s55, 2
s_cselect_b32 s28, 35840, s28
s_cmp_eq_u32 s55, 3
s_cselect_b32 s28, 40960, s28
s_mov_b32 s29, 46080
s_cmp_eq_u32 s55, 1
s_cselect_b32 s29, 51200, s29
s_cmp_eq_u32 s55, 2
s_cselect_b32 s29, 56320, s29
s_cmp_eq_u32 s55, 3
s_cselect_b32 s29, 117760, s29
s_mov_b32 s30, 122880
s_cmp_eq_u32 s55, 1
s_cselect_b32 s30, 61440, s30
s_cmp_eq_u32 s55, 2
s_cselect_b32 s30, 66560, s30
s_cmp_eq_u32 s55, 3
s_cselect_b32 s30, 71680, s30
s_mul_i32 s31, s55, 5120
s_add_u32 s31, s31, 76800
s_mul_i32 s32, s55, 5120
s_add_u32 s32, s32, 128000
s_mul_i32 s33, s55, 5120
s_add_u32 s33, s33, 0
s_mov_b32 s34, 20480
s_cmp_eq_u32 s55, 1
s_cselect_b32 s34, 25600, s34
s_cmp_eq_u32 s55, 2
s_cselect_b32 s34, 30720, s34
s_cmp_eq_u32 s55, 3
s_cselect_b32 s34, 97280, s34
s_mov_b32 s35, 102400
s_cmp_eq_u32 s55, 1
s_cselect_b32 s35, 107520, s35
s_cmp_eq_u32 s55, 2
s_cselect_b32 s35, 112640, s35
s_cmp_eq_u32 s55, 3
s_cselect_b32 s35, 112640, s35
v_add_u32 v1, 0, v0
v_mul_u32_u24 v2, 6554, v1
v_lshrrev_b32 v2, 16, v2
v_mul_u32_u24 v3, 10, v2
v_sub_u32 v3, v1, v3
v_mul_u32_u24 v2, 1280, v2
v_lshlrev_b32 v3, 4, v3
v_add_u32 v136, v2, v3
v_add_u32 v1, 64, v0
v_mul_u32_u24 v2, 6554, v1
v_lshrrev_b32 v2, 16, v2
v_mul_u32_u24 v3, 10, v2
v_sub_u32 v3, v1, v3
v_mul_u32_u24 v2, 1280, v2
v_lshlrev_b32 v3, 4, v3
v_add_u32 v137, v2, v3
v_add_u32 v1, 128, v0
v_mul_u32_u24 v2, 6554, v1
v_lshrrev_b32 v2, 16, v2
v_mul_u32_u24 v3, 10, v2
v_sub_u32 v3, v1, v3
v_mul_u32_u24 v2, 1280, v2
v_lshlrev_b32 v3, 4, v3
v_add_u32 v138, v2, v3
v_add_u32 v1, 192, v0
v_mul_u32_u24 v2, 6554, v1
v_lshrrev_b32 v2, 16, v2
v_mul_u32_u24 v3, 10, v2
v_sub_u32 v3, v1, v3
v_mul_u32_u24 v2, 1280, v2
v_lshlrev_b32 v3, 4, v3
v_add_u32 v139, v2, v3
v_add_u32 v1, 256, v0
v_mul_u32_u24 v2, 6554, v1
v_lshrrev_b32 v2, 16, v2
v_mul_u32_u24 v3, 10, v2
v_sub_u32 v3, v1, v3
v_mul_u32_u24 v2, 1280, v2
v_lshlrev_b32 v3, 4, v3
v_add_u32 v140, v2, v3
s_add_u32 m0, s28, 0
s_add_u32 s61, s60, 0
buffer_load_dwordx4 v136, s[24:27], s61 offen  lds
s_add_u32 m0, s28, 1024
s_add_u32 s61, s60, 0
buffer_load_dwordx4 v137, s[24:27], s61 offen  lds
s_add_u32 m0, s28, 2048
s_add_u32 s61, s60, 0
buffer_load_dwordx4 v138, s[24:27], s61 offen  lds
s_add_u32 m0, s28, 3072
s_add_u32 s61, s60, 0
buffer_load_dwordx4 v139, s[24:27], s61 offen  lds
s_add_u32 m0, s28, 4096
s_add_u32 s61, s60, 0
buffer_load_dwordx4 v140, s[24:27], s61 offen  lds
s_add_u32 m0, s29, 0
s_add_u32 s61, s60, 81920
buffer_load_dwordx4 v136, s[24:27], s61 offen  lds
s_add_u32 m0, s29, 1024
s_add_u32 s61, s60, 81920
buffer_load_dwordx4 v137, s[24:27], s61 offen  lds
s_add_u32 m0, s29, 2048
s_add_u32 s61, s60, 81920
buffer_load_dwordx4 v138, s[24:27], s61 offen  lds
s_add_u32 m0, s29, 3072
s_add_u32 s61, s60, 81920
buffer_load_dwordx4 v139, s[24:27], s61 offen  lds
s_add_u32 m0, s29, 4096
s_add_u32 s61, s60, 81920
buffer_load_dwordx4 v140, s[24:27], s61 offen  lds
s_mov_b32 s65, 400000
standalone__swiglu_ffn__prompt_kernel_rdys_poll:
global_load_dword v8, v9, s[62:63] sc1
s_waitcnt vmcnt(0)
v_readfirstlane_b32 s64, v8
s_cmp_eq_u32 s64, 1
s_cbranch_scc1 standalone__swiglu_ffn__prompt_kernel_rdys_done
s_sub_u32 s65, s65, 1
s_cmp_lg_u32 s65, 0
s_cbranch_scc1 standalone__swiglu_ffn__prompt_kernel_rdys_poll
standalone__swiglu_ffn__prompt_kernel_rdys_done:
s_add_u32 m0, s30, 0
s_add_u32 s61, s66, 20480
buffer_load_dwordx4 v10, s[20:23], s61 offen sc1 lds
s_add_u32 m0, s30, 1024
s_add_u32 s61, s66, 21504
buffer_load_dwordx4 v10, s[20:23], s61 offen sc1 lds
s_add_u32 m0, s30, 2048
s_add_u32 s61, s66, 22528
buffer_load_dwordx4 v10, s[20:23], s61 offen sc1 lds
s_add_u32 m0, s30, 3072
s_add_u32 s61, s66, 23552
buffer_load_dwordx4 v10, s[20:23], s61 offen sc1 lds
s_add_u32 m0, s30, 4096
s_add_u32 s61, s66, 24576
buffer_load_dwordx4 v10, s[20:23], s61 offen sc1 lds
s_add_u32 m0, s31, 0
s_add_u32 s61, s66, 30720
buffer_load_dwordx4 v10, s[20:23], s61 offen sc1 lds
s_add_u32 m0, s31, 1024
s_add_u32 s61, s66, 31744
buffer_load_dwordx4 v10, s[20:23], s61 offen sc1 lds
s_add_u32 m0, s31, 2048
s_add_u32 s61, s66, 32768
buffer_load_dwordx4 v10, s[20:23], s61 offen sc1 lds
s_add_u32 m0, s31, 3072
s_add_u32 s61, s66, 33792
buffer_load_dwordx4 v10, s[20:23], s61 offen sc1 lds
s_add_u32 m0, s31, 4096
s_add_u32 s61, s66, 34816
buffer_load_dwordx4 v10, s[20:23], s61 offen sc1 lds
s_add_u32 m0, s32, 0
s_add_u32 s61, s66, 40960
buffer_load_dwordx4 v10, s[20:23], s61 offen sc1 lds
s_add_u32 m0, s32, 1024
s_add_u32 s61, s66, 41984
buffer_load_dwordx4 v10, s[20:23], s61 offen sc1 lds
s_add_u32 m0, s32, 2048
s_add_u32 s61, s66, 43008
buffer_load_dwordx4 v10, s[20:23], s61 offen sc1 lds
s_add_u32 m0, s32, 3072
s_add_u32 s61, s66, 44032
buffer_load_dwordx4 v10, s[20:23], s61 offen sc1 lds
s_add_u32 m0, s32, 4096
s_add_u32 s61, s66, 45056
buffer_load_dwordx4 v10, s[20:23], s61 offen sc1 lds
s_waitcnt vmcnt(0)
s_barrier
s_add_u32 m0, s33, 0
s_add_u32 s61, s66, 51200
buffer_load_dwordx4 v10, s[20:23], s61 offen sc1 lds
s_add_u32 m0, s33, 1024
s_add_u32 s61, s66, 52224
buffer_load_dwordx4 v10, s[20:23], s61 offen sc1 lds
s_add_u32 m0, s33, 2048
s_add_u32 s61, s66, 53248
buffer_load_dwordx4 v10, s[20:23], s61 offen sc1 lds
s_add_u32 m0, s33, 3072
s_add_u32 s61, s66, 54272
buffer_load_dwordx4 v10, s[20:23], s61 offen sc1 lds
s_add_u32 m0, s33, 4096
s_add_u32 s61, s66, 55296
buffer_load_dwordx4 v10, s[20:23], s61 offen sc1 lds
s_add_u32 m0, s34, 0
s_add_u32 s61, s66, 61440
buffer_load_dwordx4 v10, s[20:23], s61 offen sc1 lds
s_add_u32 m0, s34, 1024
s_add_u32 s61, s66, 62464
buffer_load_dwordx4 v10, s[20:23], s61 offen sc1 lds
s_add_u32 m0, s34, 2048
s_add_u32 s61, s66, 63488
buffer_load_dwordx4 v10, s[20:23], s61 offen sc1 lds
s_add_u32 m0, s34, 3072
s_add_u32 s61, s66, 64512
buffer_load_dwordx4 v10, s[20:23], s61 offen sc1 lds
s_add_u32 m0, s34, 4096
s_add_u32 s61, s66, 65536
buffer_load_dwordx4 v10, s[20:23], s61 offen sc1 lds
s_add_u32 s61, s66, 71680
buffer_load_dwordx4 v[16:19], v10, s[20:23], s61 offen sc1
s_add_u32 s61, s66, 72704
buffer_load_dwordx4 v[20:23], v10, s[20:23], s61 offen sc1
s_add_u32 s61, s66, 73728
buffer_load_dwordx4 v[24:27], v10, s[20:23], s61 offen sc1
s_add_u32 s61, s66, 74752
buffer_load_dwordx4 v[28:31], v10, s[20:23], s61 offen sc1
s_add_u32 s61, s66, 75776
buffer_load_dwordx4 v[32:35], v10, s[20:23], s61 offen sc1
s_add_u32 s61, s66, 81920
buffer_load_dwordx4 v[36:39], v10, s[20:23], s61 offen sc1
s_add_u32 s61, s66, 82944
buffer_load_dwordx4 v[40:43], v10, s[20:23], s61 offen sc1
s_add_u32 s61, s66, 83968
buffer_load_dwordx4 v[44:47], v10, s[20:23], s61 offen sc1
s_add_u32 s61, s66, 84992
buffer_load_dwordx4 v[48:51], v10, s[20:23], s61 offen sc1
s_add_u32 s61, s66, 86016
buffer_load_dwordx4 v[52:55], v10, s[20:23], s61 offen sc1
s_add_u32 s61, s66, 92160
buffer_load_dwordx4 v[56:59], v10, s[20:23], s61 offen sc1
s_add_u32 s61, s66, 93184
buffer_load_dwordx4 v[60:63], v10, s[20:23], s61 offen sc1
s_add_u32 s61, s66, 94208
buffer_load_dwordx4 v[64:67], v10, s[20:23], s61 offen sc1
s_add_u32 s61, s66, 95232
buffer_load_dwordx4 v[68:71], v10, s[20:23], s61 offen sc1
s_add_u32 s61, s66, 96256
buffer_load_dwordx4 v[72:75], v10, s[20:23], s61 offen sc1
s_add_u32 s61, s66, 102400
buffer_load_dwordx4 v[76:79], v10, s[20:23], s61 offen sc1
s_add_u32 s61, s66, 103424
buffer_load_dwordx4 v[80:83], v10, s[20:23], s61 offen sc1
s_add_u32 s61, s66, 104448
buffer_load_dwordx4 v[84:87], v10, s[20:23], s61 offen sc1
s_add_u32 s61, s66, 105472
buffer_load_dwordx4 v[88:91], v10, s[20:23], s61 offen sc1
s_add_u32 s61, s66, 106496
buffer_load_dwordx4 v[92:95], v10, s[20:23], s61 offen sc1
s_add_u32 m0, s35, 0
s_add_u32 s61, s66, 133120
buffer_load_dwordx4 v10, s[20:23], s61 offen sc1 lds
s_add_u32 m0, s35, 1024
s_add_u32 s61, s66, 134144
buffer_load_dwordx4 v10, s[20:23], s61 offen sc1 lds
s_add_u32 m0, s35, 2048
s_add_u32 s61, s66, 135168
buffer_load_dwordx4 v10, s[20:23], s61 offen sc1 lds
s_add_u32 m0, s35, 3072
s_add_u32 s61, s66, 136192
buffer_load_dwordx4 v10, s[20:23], s61 offen sc1 lds
s_add_u32 m0, s35, 4096
s_add_u32 s61, s66, 137216
buffer_load_dwordx4 v10, s[20:23], s61 offen sc1 lds
s_add_u32 s61, s66, 112640
buffer_load_dwordx4 v[96:99], v10, s[20:23], s61 offen sc1
s_add_u32 s61, s66, 113664
buffer_load_dwordx4 v[100:103], v10, s[20:23], s61 offen sc1
s_add_u32 s61, s66, 114688
buffer_load_dwordx4 v[104:107], v10, s[20:23], s61 offen sc1
s_add_u32 s61, s66, 115712
buffer_load_dwordx4 v[108:111], v10, s[20:23], s61 offen sc1
s_add_u32 s61, s66, 116736
buffer_load_dwordx4 v[112:115], v10, s[20:23], s61 offen sc1
s_add_u32 s61, s66, 122880
buffer_load_dwordx4 v[116:119], v10, s[20:23], s61 offen sc1
s_add_u32 s61, s66, 123904
buffer_load_dwordx4 v[120:123], v10, s[20:23], s61 offen sc1
s_add_u32 s61, s66, 124928
buffer_load_dwordx4 v[124:127], v10, s[20:23], s61 offen sc1
s_add_u32 s61, s66, 125952
buffer_load_dwordx4 v[128:131], v10, s[20:23], s61 offen sc1
s_add_u32 s61, s66, 126976
buffer_load_dwordx4 v[132:135], v10, s[20:23], s61 offen sc1
v_mov_b32 v12, 163584
s_mov_b32 s65, 400000
standalone__swiglu_ffn__prompt_kernel_ys_poll:
ds_read_b32 v13, v12 offset:16
s_waitcnt lgkmcnt(0)
v_readfirstlane_b32 s64, v13
s_cmp_ge_u32 s64, 4
s_cbranch_scc1 standalone__swiglu_ffn__prompt_kernel_ys_done
s_sub_u32 s65, s65, 1
s_cmp_lg_u32 s65, 0
s_cbranch_scc1 standalone__swiglu_ffn__prompt_kernel_ys_poll
standalone__swiglu_ffn__prompt_kernel_ys_done:
s_waitcnt vmcnt(25)
v_add_u32 v12, s28, v10
ds_write_b128 v12, v[16:19] offset:0
ds_write_b128 v12, v[20:23] offset:1024
ds_write_b128 v12, v[24:27] offset:2048
ds_write_b128 v12, v[28:31] offset:3072
ds_write_b128 v12, v[32:35] offset:4096
v_add_u32 v12, s29, v10
ds_write_b128 v12, v[36:39] offset:0
ds_write_b128 v12, v[40:43] offset:1024
ds_write_b128 v12, v[44:47] offset:2048
ds_write_b128 v12, v[48:51] offset:3072
ds_write_b128 v12, v[52:55] offset:4096
s_waitcnt vmcnt(35) lgkmcnt(0)
s_barrier
s_waitcnt vmcnt(15)
v_add_u32 v12, s30, v10
ds_write_b128 v12, v[56:59] offset:0
ds_write_b128 v12, v[60:63] offset:1024
ds_write_b128 v12, v[64:67] offset:2048
ds_write_b128 v12, v[68:71] offset:3072
ds_write_b128 v12, v[72:75] offset:4096
v_add_u32 v12, s31, v10
ds_write_b128 v12, v[76:79] offset:0
ds_write_b128 v12, v[80:83] offset:1024
ds_write_b128 v12, v[84:87] offset:2048
ds_write_b128 v12, v[88:91] offset:3072
ds_write_b128 v12, v[92:95] offset:4096
s_waitcnt vmcnt(0) lgkmcnt(0)
s_barrier
s_waitcnt vmcnt(0)
v_add_u32 v12, s32, v10
ds_write_b128 v12, v[96:99] offset:0
ds_write_b128 v12, v[100:103] offset:1024
ds_write_b128 v12, v[104:107] offset:2048
ds_write_b128 v12, v[108:111] offset:3072
ds_write_b128 v12, v[112:115] offset:4096
v_add_u32 v12, s33, v10
ds_write_b128 v12, v[116:119] offset:0
ds_write_b128 v12, v[120:123] offset:1024
ds_write_b128 v12, v[124:127] offset:2048
ds_write_b128 v12, v[128:131] offset:3072
ds_write_b128 v12, v[132:135] offset:4096
s_waitcnt lgkmcnt(0)
s_barrier
s_barrier
s_endpgm
standalone__swiglu_ffn__prompt_kernel_cw:
v_mov_b32 v20, 0
v_mov_b32 v21, 0
v_mov_b32 v22, 0
v_mov_b32 v23, 0
v_mov_b32 v12, 163584
ds_write_b128 v12, v[20:23]
ds_write_b128 v12, v[20:23] offset:16
ds_write_b128 v12, v[20:23] offset:32
s_lshr_b32 s55, s3, 1
s_and_b32 s56, s3, 1
v_and_b32 v16, 31, v0
v_lshlrev_b32 v16, 2, v16
s_waitcnt lgkmcnt(0)
s_mov_b32 s20, s44
s_mov_b32 s21, s45
s_mov_b32 s22, 7077888
s_mov_b32 s23, 0x20000
s_mov_b32 s28, s40
s_mov_b32 s29, s41
s_mov_b32 s30, 2621440
s_mov_b32 s31, 0x20000
s_lshl_b32 s61, s2, 7
s_add_u32 s61, s61, 12582912
s_add_u32 s62, s44, s61
s_addc_u32 s63, s45, 0
s_cmp_lg_u32 s3, 3
s_cbranch_scc1 standalone__swiglu_ffn__prompt_kernel_nozero
v_mov_b32 v20, 0
v_mov_b32 v21, 0
v_mov_b32 v22, 0
v_mov_b32 v23, 0
s_mov_b64 exec, 0xff
global_store_dwordx4 v10, v[20:23], s[62:63] sc1
s_mov_b64 exec, -1
standalone__swiglu_ffn__prompt_kernel_nozero:
s_cmp_eq_u32 s54, 1
s_cbranch_scc1 standalone__swiglu_ffn__prompt_kernel_spare_cw
s_setprio 2
v_and_b32 v1, 15, v0
v_lshrrev_b32 v2, 4, v0
v_lshrrev_b32 v3, 1, v1
s_lshl_b32 s57, s55, 14
v_lshlrev_b32 v13, 7, v1
v_add_u32 v13, s57, v13
v_add_u32 v14, 0, v2
v_xor_b32 v14, v14, v3
v_lshlrev_b32 v14, 4, v14
v_add_u32 v4, v13, v14
v_add_u32 v6, 0x10000, v4
v_add_u32 v14, 4, v2
v_xor_b32 v14, v14, v3
v_lshlrev_b32 v14, 4, v14
v_add_u32 v5, v13, v14
v_add_u32 v7, 0x10000, v5
v_lshrrev_b32 v14, 2, v1
v_lshlrev_b32 v15, 3, v2
v_add_u32 v15, v15, v14
v_lshlrev_b32 v15, 7, v15
v_lshrrev_b32 v14, 1, v14
v_and_b32 v13, 1, v2
v_lshlrev_b32 v13, 1, v13
v_or_b32 v14, v14, v13
s_lshl_b32 s57, s56, 1
v_xor_b32 v14, s57, v14
v_lshlrev_b32 v14, 5, v14
v_add_u32 v15, v15, v14
v_and_b32 v14, 3, v0
v_lshlrev_b32 v14, 3, v14
v_add_u32 v15, v15, v14
v_add_u32 v8, 98304, v15
v_xor_b32 v9, 32, v8
s_lshl_b32 s57, s48, 4
s_lshl_b32 s58, s55, 3
s_add_u32 s57, s57, s58
s_mul_i32 s57, s57, 54
s_lshl_b32 s58, s49, 1
s_add_u32 s57, s57, s58
s_add_u32 s57, s57, s56
s_lshl_b32 s57, s57, 10
s_barrier
ds_read_b64_tr_b16 v[32:33], v8 offset:0
ds_read_b64_tr_b16 v[34:35], v8 offset:512
ds_read_b128 v[48:51], v4 offset:0
ds_read_b64_tr_b16 v[40:41], v8 offset:8192
ds_read_b64_tr_b16 v[42:43], v8 offset:8704
ds_read_b64_tr_b16 v[36:37], v9 offset:0
ds_read_b64_tr_b16 v[38:39], v9 offset:512
ds_read_b64_tr_b16 v[44:45], v9 offset:8192
ds_read_b64_tr_b16 v[46:47], v9 offset:8704
ds_read_b128 v[52:55], v4 offset:2048
ds_read_b128 v[56:59], v4 offset:4096
ds_read_b128 v[60:63], v4 offset:6144
ds_read_b128 v[64:67], v4 offset:8192
ds_read_b128 v[68:71], v4 offset:10240
ds_read_b128 v[72:75], v4 offset:12288
ds_read_b128 v[76:79], v4 offset:14336
s_cmp_lg_u32 s3, 3
s_cbranch_scc1 standalone__swiglu_ffn__prompt_kernel_noinit
s_waitcnt vmcnt(0)
s_and_b32 s61, s2, 1
s_lshl_b32 s61, s61, 7
s_add_u32 s61, s61, 64
v_mov_b32 v20, s61
v_mov_b32 v21, 1
s_mov_b64 exec, 1
global_atomic_add v20, v21, s[42:43] sc1
s_mov_b64 exec, -1
standalone__swiglu_ffn__prompt_kernel_noinit:
s_waitcnt lgkmcnt(0)
v_mfma_f32_16x16x32_bf16 v[128:131], v[32:35], v[48:51], 0
ds_read_b64_tr_b16 v[80:81], v8 offset:4096
v_mfma_f32_16x16x32_bf16 v[136:139], v[40:43], v[48:51], 0
ds_read_b64_tr_b16 v[82:83], v8 offset:4608
v_mfma_f32_16x16x32_bf16 v[132:135], v[36:39], v[48:51], 0
ds_read_b128 v[96:99], v5 offset:0
v_mfma_f32_16x16x32_bf16 v[140:143], v[44:47], v[48:51], 0
ds_read_b64_tr_b16 v[88:89], v8 offset:12288
v_mfma_f32_16x16x32_bf16 v[144:147], v[32:35], v[52:55], 0
ds_read_b64_tr_b16 v[90:91], v8 offset:12800
v_mfma_f32_16x16x32_bf16 v[152:155], v[40:43], v[52:55], 0
ds_read_b64_tr_b16 v[84:85], v9 offset:4096
v_mfma_f32_16x16x32_bf16 v[148:151], v[36:39], v[52:55], 0
ds_read_b64_tr_b16 v[86:87], v9 offset:4608
v_mfma_f32_16x16x32_bf16 v[156:159], v[44:47], v[52:55], 0
ds_read_b64_tr_b16 v[92:93], v9 offset:12288
v_mfma_f32_16x16x32_bf16 v[160:163], v[32:35], v[56:59], 0
ds_read_b64_tr_b16 v[94:95], v9 offset:12800
v_mfma_f32_16x16x32_bf16 v[168:171], v[40:43], v[56:59], 0
ds_read_b128 v[100:103], v5 offset:2048
v_mfma_f32_16x16x32_bf16 v[164:167], v[36:39], v[56:59], 0
ds_read_b128 v[104:107], v5 offset:4096
v_mfma_f32_16x16x32_bf16 v[172:175], v[44:47], v[56:59], 0
ds_read_b128 v[108:111], v5 offset:6144
v_mfma_f32_16x16x32_bf16 v[176:179], v[32:35], v[60:63], 0
ds_read_b128 v[112:115], v5 offset:8192
v_mfma_f32_16x16x32_bf16 v[184:187], v[40:43], v[60:63], 0
ds_read_b128 v[116:119], v5 offset:10240
v_mfma_f32_16x16x32_bf16 v[180:183], v[36:39], v[60:63], 0
ds_read_b128 v[120:123], v5 offset:12288
v_mfma_f32_16x16x32_bf16 v[188:191], v[44:47], v[60:63], 0
ds_read_b128 v[124:127], v5 offset:14336
v_mfma_f32_16x16x32_bf16 v[192:195], v[32:35], v[64:67], 0
v_mfma_f32_16x16x32_bf16 v[200:203], v[40:43], v[64:67], 0
v_mfma_f32_16x16x32_bf16 v[196:199], v[36:39], v[64:67], 0
v_mfma_f32_16x16x32_bf16 v[204:207], v[44:47], v[64:67], 0
v_mfma_f32_16x16x32_bf16 v[208:211], v[32:35], v[68:71], 0
v_mfma_f32_16x16x32_bf16 v[216:219], v[40:43], v[68:71], 0
v_mfma_f32_16x16x32_bf16 v[212:215], v[36:39], v[68:71], 0
v_mfma_f32_16x16x32_bf16 v[220:223], v[44:47], v[68:71], 0
v_mfma_f32_16x16x32_bf16 v[224:227], v[32:35], v[72:75], 0
v_mfma_f32_16x16x32_bf16 v[232:235], v[40:43], v[72:75], 0
v_mfma_f32_16x16x32_bf16 v[228:231], v[36:39], v[72:75], 0
v_mfma_f32_16x16x32_bf16 v[236:239], v[44:47], v[72:75], 0
v_mfma_f32_16x16x32_bf16 v[240:243], v[32:35], v[76:79], 0
v_mfma_f32_16x16x32_bf16 v[248:251], v[40:43], v[76:79], 0
v_mfma_f32_16x16x32_bf16 v[244:247], v[36:39], v[76:79], 0
v_mfma_f32_16x16x32_bf16 v[252:255], v[44:47], v[76:79], 0
s_waitcnt lgkmcnt(0)
s_barrier
v_mfma_f32_16x16x32_bf16 v[128:131], v[80:83], v[96:99], v[128:131]
ds_read_b64_tr_b16 v[32:33], v8 offset:16384
v_mfma_f32_16x16x32_bf16 v[136:139], v[88:91], v[96:99], v[136:139]
ds_read_b64_tr_b16 v[34:35], v8 offset:16896
v_mfma_f32_16x16x32_bf16 v[132:135], v[84:87], v[96:99], v[132:135]
ds_read_b128 v[48:51], v4 offset:32768
v_mfma_f32_16x16x32_bf16 v[140:143], v[92:95], v[96:99], v[140:143]
ds_read_b64_tr_b16 v[40:41], v8 offset:24576
v_mfma_f32_16x16x32_bf16 v[144:147], v[80:83], v[100:103], v[144:147]
ds_read_b64_tr_b16 v[42:43], v8 offset:25088
v_mfma_f32_16x16x32_bf16 v[152:155], v[88:91], v[100:103], v[152:155]
ds_read_b64_tr_b16 v[36:37], v9 offset:16384
v_mfma_f32_16x16x32_bf16 v[148:151], v[84:87], v[100:103], v[148:151]
ds_read_b64_tr_b16 v[38:39], v9 offset:16896
v_mfma_f32_16x16x32_bf16 v[156:159], v[92:95], v[100:103], v[156:159]
ds_read_b64_tr_b16 v[44:45], v9 offset:24576
v_mfma_f32_16x16x32_bf16 v[160:163], v[80:83], v[104:107], v[160:163]
ds_read_b64_tr_b16 v[46:47], v9 offset:25088
v_mfma_f32_16x16x32_bf16 v[168:171], v[88:91], v[104:107], v[168:171]
ds_read_b128 v[52:55], v4 offset:34816
v_mfma_f32_16x16x32_bf16 v[164:167], v[84:87], v[104:107], v[164:167]
ds_read_b128 v[56:59], v4 offset:36864
v_mfma_f32_16x16x32_bf16 v[172:175], v[92:95], v[104:107], v[172:175]
ds_read_b128 v[60:63], v4 offset:38912
v_mfma_f32_16x16x32_bf16 v[176:179], v[80:83], v[108:111], v[176:179]
ds_read_b128 v[64:67], v4 offset:40960
v_mfma_f32_16x16x32_bf16 v[184:187], v[88:91], v[108:111], v[184:187]
ds_read_b128 v[68:71], v4 offset:43008
v_mfma_f32_16x16x32_bf16 v[180:183], v[84:87], v[108:111], v[180:183]
ds_read_b128 v[72:75], v4 offset:45056
v_mfma_f32_16x16x32_bf16 v[188:191], v[92:95], v[108:111], v[188:191]
ds_read_b128 v[76:79], v4 offset:47104
v_mfma_f32_16x16x32_bf16 v[192:195], v[80:83], v[112:115], v[192:195]
v_mfma_f32_16x16x32_bf16 v[200:203], v[88:91], v[112:115], v[200:203]
v_mfma_f32_16x16x32_bf16 v[196:199], v[84:87], v[112:115], v[196:199]
v_mfma_f32_16x16x32_bf16 v[204:207], v[92:95], v[112:115], v[204:207]
v_mfma_f32_16x16x32_bf16 v[208:211], v[80:83], v[116:119], v[208:211]
v_mfma_f32_16x16x32_bf16 v[216:219], v[88:91], v[116:119], v[216:219]
v_mfma_f32_16x16x32_bf16 v[212:215], v[84:87], v[116:119], v[212:215]
v_mfma_f32_16x16x32_bf16 v[220:223], v[92:95], v[116:119], v[220:223]
v_mfma_f32_16x16x32_bf16 v[224:227], v[80:83], v[120:123], v[224:227]
v_mfma_f32_16x16x32_bf16 v[232:235], v[88:91], v[120:123], v[232:235]
v_mfma_f32_16x16x32_bf16 v[228:231], v[84:87], v[120:123], v[228:231]
v_mfma_f32_16x16x32_bf16 v[236:239], v[92:95], v[120:123], v[236:239]
v_mfma_f32_16x16x32_bf16 v[240:243], v[80:83], v[124:127], v[240:243]
v_mfma_f32_16x16x32_bf16 v[248:251], v[88:91], v[124:127], v[248:251]
v_mfma_f32_16x16x32_bf16 v[244:247], v[84:87], v[124:127], v[244:247]
v_mfma_f32_16x16x32_bf16 v[252:255], v[92:95], v[124:127], v[252:255]
s_waitcnt lgkmcnt(0)
v_mfma_f32_16x16x32_bf16 v[128:131], v[32:35], v[48:51], v[128:131]
ds_read_b64_tr_b16 v[80:81], v8 offset:20480
v_mfma_f32_16x16x32_bf16 v[136:139], v[40:43], v[48:51], v[136:139]
ds_read_b64_tr_b16 v[82:83], v8 offset:20992
v_mfma_f32_16x16x32_bf16 v[132:135], v[36:39], v[48:51], v[132:135]
ds_read_b128 v[96:99], v5 offset:32768
v_mfma_f32_16x16x32_bf16 v[140:143], v[44:47], v[48:51], v[140:143]
ds_read_b64_tr_b16 v[88:89], v8 offset:28672
v_mfma_f32_16x16x32_bf16 v[144:147], v[32:35], v[52:55], v[144:147]
ds_read_b64_tr_b16 v[90:91], v8 offset:29184
v_mfma_f32_16x16x32_bf16 v[152:155], v[40:43], v[52:55], v[152:155]
ds_read_b64_tr_b16 v[84:85], v9 offset:20480
v_mfma_f32_16x16x32_bf16 v[148:151], v[36:39], v[52:55], v[148:151]
ds_read_b64_tr_b16 v[86:87], v9 offset:20992
v_mfma_f32_16x16x32_bf16 v[156:159], v[44:47], v[52:55], v[156:159]
ds_read_b64_tr_b16 v[92:93], v9 offset:28672
v_mfma_f32_16x16x32_bf16 v[160:163], v[32:35], v[56:59], v[160:163]
ds_read_b64_tr_b16 v[94:95], v9 offset:29184
v_mfma_f32_16x16x32_bf16 v[168:171], v[40:43], v[56:59], v[168:171]
ds_read_b128 v[100:103], v5 offset:34816
v_mfma_f32_16x16x32_bf16 v[164:167], v[36:39], v[56:59], v[164:167]
ds_read_b128 v[104:107], v5 offset:36864
v_mfma_f32_16x16x32_bf16 v[172:175], v[44:47], v[56:59], v[172:175]
ds_read_b128 v[108:111], v5 offset:38912
v_mfma_f32_16x16x32_bf16 v[176:179], v[32:35], v[60:63], v[176:179]
ds_read_b128 v[112:115], v5 offset:40960
v_mfma_f32_16x16x32_bf16 v[184:187], v[40:43], v[60:63], v[184:187]
ds_read_b128 v[116:119], v5 offset:43008
v_mfma_f32_16x16x32_bf16 v[180:183], v[36:39], v[60:63], v[180:183]
ds_read_b128 v[120:123], v5 offset:45056
v_mfma_f32_16x16x32_bf16 v[188:191], v[44:47], v[60:63], v[188:191]
ds_read_b128 v[124:127], v5 offset:47104
v_mfma_f32_16x16x32_bf16 v[192:195], v[32:35], v[64:67], v[192:195]
v_mfma_f32_16x16x32_bf16 v[200:203], v[40:43], v[64:67], v[200:203]
v_mfma_f32_16x16x32_bf16 v[196:199], v[36:39], v[64:67], v[196:199]
v_mfma_f32_16x16x32_bf16 v[204:207], v[44:47], v[64:67], v[204:207]
v_mfma_f32_16x16x32_bf16 v[208:211], v[32:35], v[68:71], v[208:211]
v_mfma_f32_16x16x32_bf16 v[216:219], v[40:43], v[68:71], v[216:219]
v_mfma_f32_16x16x32_bf16 v[212:215], v[36:39], v[68:71], v[212:215]
v_mfma_f32_16x16x32_bf16 v[220:223], v[44:47], v[68:71], v[220:223]
v_mfma_f32_16x16x32_bf16 v[224:227], v[32:35], v[72:75], v[224:227]
v_mfma_f32_16x16x32_bf16 v[232:235], v[40:43], v[72:75], v[232:235]
v_mfma_f32_16x16x32_bf16 v[228:231], v[36:39], v[72:75], v[228:231]
v_mfma_f32_16x16x32_bf16 v[236:239], v[44:47], v[72:75], v[236:239]
v_mfma_f32_16x16x32_bf16 v[240:243], v[32:35], v[76:79], v[240:243]
v_mfma_f32_16x16x32_bf16 v[248:251], v[40:43], v[76:79], v[248:251]
v_mfma_f32_16x16x32_bf16 v[244:247], v[36:39], v[76:79], v[244:247]
v_mfma_f32_16x16x32_bf16 v[252:255], v[44:47], v[76:79], v[252:255]
s_waitcnt lgkmcnt(0)
s_barrier
v_mfma_f32_16x16x32_bf16 v[128:131], v[80:83], v[96:99], v[128:131]
ds_read_b64_tr_b16 v[32:33], v8 offset:32768
v_mfma_f32_16x16x32_bf16 v[136:139], v[88:91], v[96:99], v[136:139]
ds_read_b64_tr_b16 v[34:35], v8 offset:33280
v_mfma_f32_16x16x32_bf16 v[132:135], v[84:87], v[96:99], v[132:135]
ds_read_b128 v[48:51], v6 offset:0
v_mfma_f32_16x16x32_bf16 v[140:143], v[92:95], v[96:99], v[140:143]
ds_read_b64_tr_b16 v[40:41], v8 offset:40960
v_mfma_f32_16x16x32_bf16 v[144:147], v[80:83], v[100:103], v[144:147]
ds_read_b64_tr_b16 v[42:43], v8 offset:41472
v_mfma_f32_16x16x32_bf16 v[152:155], v[88:91], v[100:103], v[152:155]
ds_read_b64_tr_b16 v[36:37], v9 offset:32768
v_mfma_f32_16x16x32_bf16 v[148:151], v[84:87], v[100:103], v[148:151]
ds_read_b64_tr_b16 v[38:39], v9 offset:33280
v_mfma_f32_16x16x32_bf16 v[156:159], v[92:95], v[100:103], v[156:159]
ds_read_b64_tr_b16 v[44:45], v9 offset:40960
v_mfma_f32_16x16x32_bf16 v[160:163], v[80:83], v[104:107], v[160:163]
ds_read_b64_tr_b16 v[46:47], v9 offset:41472
v_mfma_f32_16x16x32_bf16 v[168:171], v[88:91], v[104:107], v[168:171]
ds_read_b128 v[52:55], v6 offset:2048
v_mfma_f32_16x16x32_bf16 v[164:167], v[84:87], v[104:107], v[164:167]
ds_read_b128 v[56:59], v6 offset:4096
v_mfma_f32_16x16x32_bf16 v[172:175], v[92:95], v[104:107], v[172:175]
ds_read_b128 v[60:63], v6 offset:6144
v_mfma_f32_16x16x32_bf16 v[176:179], v[80:83], v[108:111], v[176:179]
ds_read_b128 v[64:67], v6 offset:8192
v_mfma_f32_16x16x32_bf16 v[184:187], v[88:91], v[108:111], v[184:187]
ds_read_b128 v[68:71], v6 offset:10240
v_mfma_f32_16x16x32_bf16 v[180:183], v[84:87], v[108:111], v[180:183]
ds_read_b128 v[72:75], v6 offset:12288
v_mfma_f32_16x16x32_bf16 v[188:191], v[92:95], v[108:111], v[188:191]
ds_read_b128 v[76:79], v6 offset:14336
v_mfma_f32_16x16x32_bf16 v[192:195], v[80:83], v[112:115], v[192:195]
v_mfma_f32_16x16x32_bf16 v[200:203], v[88:91], v[112:115], v[200:203]
v_mfma_f32_16x16x32_bf16 v[196:199], v[84:87], v[112:115], v[196:199]
v_mfma_f32_16x16x32_bf16 v[204:207], v[92:95], v[112:115], v[204:207]
v_mfma_f32_16x16x32_bf16 v[208:211], v[80:83], v[116:119], v[208:211]
v_mfma_f32_16x16x32_bf16 v[216:219], v[88:91], v[116:119], v[216:219]
v_mfma_f32_16x16x32_bf16 v[212:215], v[84:87], v[116:119], v[212:215]
v_mfma_f32_16x16x32_bf16 v[220:223], v[92:95], v[116:119], v[220:223]
v_mfma_f32_16x16x32_bf16 v[224:227], v[80:83], v[120:123], v[224:227]
v_mfma_f32_16x16x32_bf16 v[232:235], v[88:91], v[120:123], v[232:235]
v_mfma_f32_16x16x32_bf16 v[228:231], v[84:87], v[120:123], v[228:231]
v_mfma_f32_16x16x32_bf16 v[236:239], v[92:95], v[120:123], v[236:239]
v_mfma_f32_16x16x32_bf16 v[240:243], v[80:83], v[124:127], v[240:243]
v_mfma_f32_16x16x32_bf16 v[248:251], v[88:91], v[124:127], v[248:251]
v_mfma_f32_16x16x32_bf16 v[244:247], v[84:87], v[124:127], v[244:247]
v_mfma_f32_16x16x32_bf16 v[252:255], v[92:95], v[124:127], v[252:255]
s_waitcnt lgkmcnt(0)
v_mfma_f32_16x16x32_bf16 v[128:131], v[32:35], v[48:51], v[128:131]
ds_read_b64_tr_b16 v[80:81], v8 offset:36864
v_mfma_f32_16x16x32_bf16 v[136:139], v[40:43], v[48:51], v[136:139]
ds_read_b64_tr_b16 v[82:83], v8 offset:37376
v_mfma_f32_16x16x32_bf16 v[132:135], v[36:39], v[48:51], v[132:135]
ds_read_b128 v[96:99], v7 offset:0
v_mfma_f32_16x16x32_bf16 v[140:143], v[44:47], v[48:51], v[140:143]
ds_read_b64_tr_b16 v[88:89], v8 offset:45056
v_mfma_f32_16x16x32_bf16 v[144:147], v[32:35], v[52:55], v[144:147]
ds_read_b64_tr_b16 v[90:91], v8 offset:45568
v_mfma_f32_16x16x32_bf16 v[152:155], v[40:43], v[52:55], v[152:155]
ds_read_b64_tr_b16 v[84:85], v9 offset:36864
v_mfma_f32_16x16x32_bf16 v[148:151], v[36:39], v[52:55], v[148:151]
ds_read_b64_tr_b16 v[86:87], v9 offset:37376
v_mfma_f32_16x16x32_bf16 v[156:159], v[44:47], v[52:55], v[156:159]
ds_read_b64_tr_b16 v[92:93], v9 offset:45056
v_mfma_f32_16x16x32_bf16 v[160:163], v[32:35], v[56:59], v[160:163]
ds_read_b64_tr_b16 v[94:95], v9 offset:45568
v_mfma_f32_16x16x32_bf16 v[168:171], v[40:43], v[56:59], v[168:171]
ds_read_b128 v[100:103], v7 offset:2048
v_mfma_f32_16x16x32_bf16 v[164:167], v[36:39], v[56:59], v[164:167]
ds_read_b128 v[104:107], v7 offset:4096
v_mfma_f32_16x16x32_bf16 v[172:175], v[44:47], v[56:59], v[172:175]
ds_read_b128 v[108:111], v7 offset:6144
v_mfma_f32_16x16x32_bf16 v[176:179], v[32:35], v[60:63], v[176:179]
ds_read_b128 v[112:115], v7 offset:8192
v_mfma_f32_16x16x32_bf16 v[184:187], v[40:43], v[60:63], v[184:187]
ds_read_b128 v[116:119], v7 offset:10240
v_mfma_f32_16x16x32_bf16 v[180:183], v[36:39], v[60:63], v[180:183]
ds_read_b128 v[120:123], v7 offset:12288
v_mfma_f32_16x16x32_bf16 v[188:191], v[44:47], v[60:63], v[188:191]
ds_read_b128 v[124:127], v7 offset:14336
v_mfma_f32_16x16x32_bf16 v[192:195], v[32:35], v[64:67], v[192:195]
v_mfma_f32_16x16x32_bf16 v[200:203], v[40:43], v[64:67], v[200:203]
v_mfma_f32_16x16x32_bf16 v[196:199], v[36:39], v[64:67], v[196:199]
v_mfma_f32_16x16x32_bf16 v[204:207], v[44:47], v[64:67], v[204:207]
v_mfma_f32_16x16x32_bf16 v[208:211], v[32:35], v[68:71], v[208:211]
v_mfma_f32_16x16x32_bf16 v[216:219], v[40:43], v[68:71], v[216:219]
v_mfma_f32_16x16x32_bf16 v[212:215], v[36:39], v[68:71], v[212:215]
v_mfma_f32_16x16x32_bf16 v[220:223], v[44:47], v[68:71], v[220:223]
v_mfma_f32_16x16x32_bf16 v[224:227], v[32:35], v[72:75], v[224:227]
v_mfma_f32_16x16x32_bf16 v[232:235], v[40:43], v[72:75], v[232:235]
v_mfma_f32_16x16x32_bf16 v[228:231], v[36:39], v[72:75], v[228:231]
v_mfma_f32_16x16x32_bf16 v[236:239], v[44:47], v[72:75], v[236:239]
v_mfma_f32_16x16x32_bf16 v[240:243], v[32:35], v[76:79], v[240:243]
v_mfma_f32_16x16x32_bf16 v[248:251], v[40:43], v[76:79], v[248:251]
v_mfma_f32_16x16x32_bf16 v[244:247], v[36:39], v[76:79], v[244:247]
v_mfma_f32_16x16x32_bf16 v[252:255], v[44:47], v[76:79], v[252:255]
s_waitcnt lgkmcnt(0)
s_barrier
v_mfma_f32_16x16x32_bf16 v[128:131], v[80:83], v[96:99], v[128:131]
ds_read_b64_tr_b16 v[32:33], v8 offset:0
v_mfma_f32_16x16x32_bf16 v[136:139], v[88:91], v[96:99], v[136:139]
ds_read_b64_tr_b16 v[34:35], v8 offset:512
v_mfma_f32_16x16x32_bf16 v[132:135], v[84:87], v[96:99], v[132:135]
ds_read_b128 v[48:51], v4 offset:0
v_mfma_f32_16x16x32_bf16 v[140:143], v[92:95], v[96:99], v[140:143]
ds_read_b64_tr_b16 v[40:41], v8 offset:8192
v_mfma_f32_16x16x32_bf16 v[144:147], v[80:83], v[100:103], v[144:147]
ds_read_b64_tr_b16 v[42:43], v8 offset:8704
v_mfma_f32_16x16x32_bf16 v[152:155], v[88:91], v[100:103], v[152:155]
ds_read_b64_tr_b16 v[36:37], v9 offset:0
v_mfma_f32_16x16x32_bf16 v[148:151], v[84:87], v[100:103], v[148:151]
ds_read_b64_tr_b16 v[38:39], v9 offset:512
v_mfma_f32_16x16x32_bf16 v[156:159], v[92:95], v[100:103], v[156:159]
ds_read_b64_tr_b16 v[44:45], v9 offset:8192
v_mfma_f32_16x16x32_bf16 v[160:163], v[80:83], v[104:107], v[160:163]
ds_read_b64_tr_b16 v[46:47], v9 offset:8704
v_mfma_f32_16x16x32_bf16 v[168:171], v[88:91], v[104:107], v[168:171]
ds_read_b128 v[52:55], v4 offset:2048
v_mfma_f32_16x16x32_bf16 v[164:167], v[84:87], v[104:107], v[164:167]
ds_read_b128 v[56:59], v4 offset:4096
v_mfma_f32_16x16x32_bf16 v[172:175], v[92:95], v[104:107], v[172:175]
ds_read_b128 v[60:63], v4 offset:6144
v_mfma_f32_16x16x32_bf16 v[176:179], v[80:83], v[108:111], v[176:179]
ds_read_b128 v[64:67], v4 offset:8192
v_mfma_f32_16x16x32_bf16 v[184:187], v[88:91], v[108:111], v[184:187]
ds_read_b128 v[68:71], v4 offset:10240
v_mfma_f32_16x16x32_bf16 v[180:183], v[84:87], v[108:111], v[180:183]
ds_read_b128 v[72:75], v4 offset:12288
v_mfma_f32_16x16x32_bf16 v[188:191], v[92:95], v[108:111], v[188:191]
ds_read_b128 v[76:79], v4 offset:14336
v_mfma_f32_16x16x32_bf16 v[192:195], v[80:83], v[112:115], v[192:195]
v_mfma_f32_16x16x32_bf16 v[200:203], v[88:91], v[112:115], v[200:203]
v_mfma_f32_16x16x32_bf16 v[196:199], v[84:87], v[112:115], v[196:199]
v_mfma_f32_16x16x32_bf16 v[204:207], v[92:95], v[112:115], v[204:207]
v_mfma_f32_16x16x32_bf16 v[208:211], v[80:83], v[116:119], v[208:211]
v_mfma_f32_16x16x32_bf16 v[216:219], v[88:91], v[116:119], v[216:219]
v_mfma_f32_16x16x32_bf16 v[212:215], v[84:87], v[116:119], v[212:215]
v_mfma_f32_16x16x32_bf16 v[220:223], v[92:95], v[116:119], v[220:223]
v_mfma_f32_16x16x32_bf16 v[224:227], v[80:83], v[120:123], v[224:227]
v_mfma_f32_16x16x32_bf16 v[232:235], v[88:91], v[120:123], v[232:235]
v_mfma_f32_16x16x32_bf16 v[228:231], v[84:87], v[120:123], v[228:231]
v_mfma_f32_16x16x32_bf16 v[236:239], v[92:95], v[120:123], v[236:239]
v_mfma_f32_16x16x32_bf16 v[240:243], v[80:83], v[124:127], v[240:243]
v_mfma_f32_16x16x32_bf16 v[248:251], v[88:91], v[124:127], v[248:251]
v_mfma_f32_16x16x32_bf16 v[244:247], v[84:87], v[124:127], v[244:247]
v_mfma_f32_16x16x32_bf16 v[252:255], v[92:95], v[124:127], v[252:255]
s_waitcnt lgkmcnt(0)
v_mfma_f32_16x16x32_bf16 v[128:131], v[32:35], v[48:51], v[128:131]
ds_read_b64_tr_b16 v[80:81], v8 offset:4096
v_mfma_f32_16x16x32_bf16 v[136:139], v[40:43], v[48:51], v[136:139]
ds_read_b64_tr_b16 v[82:83], v8 offset:4608
v_mfma_f32_16x16x32_bf16 v[132:135], v[36:39], v[48:51], v[132:135]
ds_read_b128 v[96:99], v5 offset:0
v_mfma_f32_16x16x32_bf16 v[140:143], v[44:47], v[48:51], v[140:143]
ds_read_b64_tr_b16 v[88:89], v8 offset:12288
v_mfma_f32_16x16x32_bf16 v[144:147], v[32:35], v[52:55], v[144:147]
ds_read_b64_tr_b16 v[90:91], v8 offset:12800
v_mfma_f32_16x16x32_bf16 v[152:155], v[40:43], v[52:55], v[152:155]
ds_read_b64_tr_b16 v[84:85], v9 offset:4096
v_mfma_f32_16x16x32_bf16 v[148:151], v[36:39], v[52:55], v[148:151]
ds_read_b64_tr_b16 v[86:87], v9 offset:4608
v_mfma_f32_16x16x32_bf16 v[156:159], v[44:47], v[52:55], v[156:159]
ds_read_b64_tr_b16 v[92:93], v9 offset:12288
v_mfma_f32_16x16x32_bf16 v[160:163], v[32:35], v[56:59], v[160:163]
ds_read_b64_tr_b16 v[94:95], v9 offset:12800
v_mfma_f32_16x16x32_bf16 v[168:171], v[40:43], v[56:59], v[168:171]
ds_read_b128 v[100:103], v5 offset:2048
v_mfma_f32_16x16x32_bf16 v[164:167], v[36:39], v[56:59], v[164:167]
ds_read_b128 v[104:107], v5 offset:4096
v_mfma_f32_16x16x32_bf16 v[172:175], v[44:47], v[56:59], v[172:175]
ds_read_b128 v[108:111], v5 offset:6144
v_mfma_f32_16x16x32_bf16 v[176:179], v[32:35], v[60:63], v[176:179]
ds_read_b128 v[112:115], v5 offset:8192
v_mfma_f32_16x16x32_bf16 v[184:187], v[40:43], v[60:63], v[184:187]
ds_read_b128 v[116:119], v5 offset:10240
v_mfma_f32_16x16x32_bf16 v[180:183], v[36:39], v[60:63], v[180:183]
ds_read_b128 v[120:123], v5 offset:12288
v_mfma_f32_16x16x32_bf16 v[188:191], v[44:47], v[60:63], v[188:191]
ds_read_b128 v[124:127], v5 offset:14336
v_mfma_f32_16x16x32_bf16 v[192:195], v[32:35], v[64:67], v[192:195]
v_mfma_f32_16x16x32_bf16 v[200:203], v[40:43], v[64:67], v[200:203]
v_mfma_f32_16x16x32_bf16 v[196:199], v[36:39], v[64:67], v[196:199]
v_mfma_f32_16x16x32_bf16 v[204:207], v[44:47], v[64:67], v[204:207]
v_mfma_f32_16x16x32_bf16 v[208:211], v[32:35], v[68:71], v[208:211]
v_mfma_f32_16x16x32_bf16 v[216:219], v[40:43], v[68:71], v[216:219]
v_mfma_f32_16x16x32_bf16 v[212:215], v[36:39], v[68:71], v[212:215]
v_mfma_f32_16x16x32_bf16 v[220:223], v[44:47], v[68:71], v[220:223]
v_mfma_f32_16x16x32_bf16 v[224:227], v[32:35], v[72:75], v[224:227]
v_mfma_f32_16x16x32_bf16 v[232:235], v[40:43], v[72:75], v[232:235]
v_mfma_f32_16x16x32_bf16 v[228:231], v[36:39], v[72:75], v[228:231]
v_mfma_f32_16x16x32_bf16 v[236:239], v[44:47], v[72:75], v[236:239]
v_mfma_f32_16x16x32_bf16 v[240:243], v[32:35], v[76:79], v[240:243]
v_mfma_f32_16x16x32_bf16 v[248:251], v[40:43], v[76:79], v[248:251]
v_mfma_f32_16x16x32_bf16 v[244:247], v[36:39], v[76:79], v[244:247]
v_mfma_f32_16x16x32_bf16 v[252:255], v[44:47], v[76:79], v[252:255]
s_waitcnt lgkmcnt(0)
s_barrier
v_mfma_f32_16x16x32_bf16 v[128:131], v[80:83], v[96:99], v[128:131]
ds_read_b64_tr_b16 v[32:33], v8 offset:16384
v_mfma_f32_16x16x32_bf16 v[136:139], v[88:91], v[96:99], v[136:139]
ds_read_b64_tr_b16 v[34:35], v8 offset:16896
v_mfma_f32_16x16x32_bf16 v[132:135], v[84:87], v[96:99], v[132:135]
ds_read_b128 v[48:51], v4 offset:32768
v_mfma_f32_16x16x32_bf16 v[140:143], v[92:95], v[96:99], v[140:143]
ds_read_b64_tr_b16 v[40:41], v8 offset:24576
v_mfma_f32_16x16x32_bf16 v[144:147], v[80:83], v[100:103], v[144:147]
ds_read_b64_tr_b16 v[42:43], v8 offset:25088
v_mfma_f32_16x16x32_bf16 v[152:155], v[88:91], v[100:103], v[152:155]
ds_read_b64_tr_b16 v[36:37], v9 offset:16384
v_mfma_f32_16x16x32_bf16 v[148:151], v[84:87], v[100:103], v[148:151]
ds_read_b64_tr_b16 v[38:39], v9 offset:16896
v_mfma_f32_16x16x32_bf16 v[156:159], v[92:95], v[100:103], v[156:159]
ds_read_b64_tr_b16 v[44:45], v9 offset:24576
v_mfma_f32_16x16x32_bf16 v[160:163], v[80:83], v[104:107], v[160:163]
ds_read_b64_tr_b16 v[46:47], v9 offset:25088
v_mfma_f32_16x16x32_bf16 v[168:171], v[88:91], v[104:107], v[168:171]
ds_read_b128 v[52:55], v4 offset:34816
v_mfma_f32_16x16x32_bf16 v[164:167], v[84:87], v[104:107], v[164:167]
ds_read_b128 v[56:59], v4 offset:36864
v_mfma_f32_16x16x32_bf16 v[172:175], v[92:95], v[104:107], v[172:175]
ds_read_b128 v[60:63], v4 offset:38912
v_mfma_f32_16x16x32_bf16 v[176:179], v[80:83], v[108:111], v[176:179]
ds_read_b128 v[64:67], v4 offset:40960
v_mfma_f32_16x16x32_bf16 v[184:187], v[88:91], v[108:111], v[184:187]
ds_read_b128 v[68:71], v4 offset:43008
v_mfma_f32_16x16x32_bf16 v[180:183], v[84:87], v[108:111], v[180:183]
ds_read_b128 v[72:75], v4 offset:45056
v_mfma_f32_16x16x32_bf16 v[188:191], v[92:95], v[108:111], v[188:191]
ds_read_b128 v[76:79], v4 offset:47104
v_mfma_f32_16x16x32_bf16 v[192:195], v[80:83], v[112:115], v[192:195]
v_mfma_f32_16x16x32_bf16 v[200:203], v[88:91], v[112:115], v[200:203]
v_mfma_f32_16x16x32_bf16 v[196:199], v[84:87], v[112:115], v[196:199]
v_mfma_f32_16x16x32_bf16 v[204:207], v[92:95], v[112:115], v[204:207]
v_mfma_f32_16x16x32_bf16 v[208:211], v[80:83], v[116:119], v[208:211]
v_mfma_f32_16x16x32_bf16 v[216:219], v[88:91], v[116:119], v[216:219]
v_mfma_f32_16x16x32_bf16 v[212:215], v[84:87], v[116:119], v[212:215]
v_mfma_f32_16x16x32_bf16 v[220:223], v[92:95], v[116:119], v[220:223]
v_mfma_f32_16x16x32_bf16 v[224:227], v[80:83], v[120:123], v[224:227]
v_mfma_f32_16x16x32_bf16 v[232:235], v[88:91], v[120:123], v[232:235]
v_mfma_f32_16x16x32_bf16 v[228:231], v[84:87], v[120:123], v[228:231]
v_mfma_f32_16x16x32_bf16 v[236:239], v[92:95], v[120:123], v[236:239]
v_mfma_f32_16x16x32_bf16 v[240:243], v[80:83], v[124:127], v[240:243]
s_cmp_lg_u32 s3, 3
s_cbranch_scc1 standalone__swiglu_ffn__prompt_kernel_noprobe
v_mov_b32 v17, 64
v_mov_b32 v18, 192
global_load_dword v17, v17, s[42:43] sc1
global_load_dword v18, v18, s[42:43] sc1
standalone__swiglu_ffn__prompt_kernel_noprobe:
v_mfma_f32_16x16x32_bf16 v[248:251], v[88:91], v[124:127], v[248:251]
v_mfma_f32_16x16x32_bf16 v[244:247], v[84:87], v[124:127], v[244:247]
v_mfma_f32_16x16x32_bf16 v[252:255], v[92:95], v[124:127], v[252:255]
s_waitcnt lgkmcnt(0)
v_mfma_f32_16x16x32_bf16 v[128:131], v[32:35], v[48:51], v[128:131]
ds_read_b64_tr_b16 v[80:81], v8 offset:20480
v_mfma_f32_16x16x32_bf16 v[136:139], v[40:43], v[48:51], v[136:139]
ds_read_b64_tr_b16 v[82:83], v8 offset:20992
v_mfma_f32_16x16x32_bf16 v[132:135], v[36:39], v[48:51], v[132:135]
ds_read_b128 v[96:99], v5 offset:32768
v_mfma_f32_16x16x32_bf16 v[140:143], v[44:47], v[48:51], v[140:143]
ds_read_b64_tr_b16 v[88:89], v8 offset:28672
v_mfma_f32_16x16x32_bf16 v[144:147], v[32:35], v[52:55], v[144:147]
ds_read_b64_tr_b16 v[90:91], v8 offset:29184
v_mfma_f32_16x16x32_bf16 v[152:155], v[40:43], v[52:55], v[152:155]
ds_read_b64_tr_b16 v[84:85], v9 offset:20480
v_mfma_f32_16x16x32_bf16 v[148:151], v[36:39], v[52:55], v[148:151]
ds_read_b64_tr_b16 v[86:87], v9 offset:20992
v_mfma_f32_16x16x32_bf16 v[156:159], v[44:47], v[52:55], v[156:159]
ds_read_b64_tr_b16 v[92:93], v9 offset:28672
v_mfma_f32_16x16x32_bf16 v[160:163], v[32:35], v[56:59], v[160:163]
ds_read_b64_tr_b16 v[94:95], v9 offset:29184
v_mfma_f32_16x16x32_bf16 v[168:171], v[40:43], v[56:59], v[168:171]
ds_read_b128 v[100:103], v5 offset:34816
v_mfma_f32_16x16x32_bf16 v[164:167], v[36:39], v[56:59], v[164:167]
ds_read_b128 v[104:107], v5 offset:36864
v_mfma_f32_16x16x32_bf16 v[172:175], v[44:47], v[56:59], v[172:175]
ds_read_b128 v[108:111], v5 offset:38912
v_mfma_f32_16x16x32_bf16 v[176:179], v[32:35], v[60:63], v[176:179]
ds_read_b128 v[112:115], v5 offset:40960
v_mfma_f32_16x16x32_bf16 v[184:187], v[40:43], v[60:63], v[184:187]
ds_read_b128 v[116:119], v5 offset:43008
v_mfma_f32_16x16x32_bf16 v[180:183], v[36:39], v[60:63], v[180:183]
ds_read_b128 v[120:123], v5 offset:45056
v_mfma_f32_16x16x32_bf16 v[188:191], v[44:47], v[60:63], v[188:191]
ds_read_b128 v[124:127], v5 offset:47104
v_mfma_f32_16x16x32_bf16 v[192:195], v[32:35], v[64:67], v[192:195]
v_mfma_f32_16x16x32_bf16 v[200:203], v[40:43], v[64:67], v[200:203]
v_mfma_f32_16x16x32_bf16 v[196:199], v[36:39], v[64:67], v[196:199]
v_mfma_f32_16x16x32_bf16 v[204:207], v[44:47], v[64:67], v[204:207]
v_mfma_f32_16x16x32_bf16 v[208:211], v[32:35], v[68:71], v[208:211]
v_mfma_f32_16x16x32_bf16 v[216:219], v[40:43], v[68:71], v[216:219]
v_mfma_f32_16x16x32_bf16 v[212:215], v[36:39], v[68:71], v[212:215]
v_mfma_f32_16x16x32_bf16 v[220:223], v[44:47], v[68:71], v[220:223]
v_mfma_f32_16x16x32_bf16 v[224:227], v[32:35], v[72:75], v[224:227]
v_mfma_f32_16x16x32_bf16 v[232:235], v[40:43], v[72:75], v[232:235]
v_mfma_f32_16x16x32_bf16 v[228:231], v[36:39], v[72:75], v[228:231]
v_mfma_f32_16x16x32_bf16 v[236:239], v[44:47], v[72:75], v[236:239]
v_mfma_f32_16x16x32_bf16 v[240:243], v[32:35], v[76:79], v[240:243]
v_mfma_f32_16x16x32_bf16 v[248:251], v[40:43], v[76:79], v[248:251]
v_mfma_f32_16x16x32_bf16 v[244:247], v[36:39], v[76:79], v[244:247]
v_mfma_f32_16x16x32_bf16 v[252:255], v[44:47], v[76:79], v[252:255]
s_waitcnt lgkmcnt(0)
s_barrier
v_mfma_f32_16x16x32_bf16 v[128:131], v[80:83], v[96:99], v[128:131]
ds_read_b64_tr_b16 v[32:33], v8 offset:32768
v_mfma_f32_16x16x32_bf16 v[136:139], v[88:91], v[96:99], v[136:139]
ds_read_b64_tr_b16 v[34:35], v8 offset:33280
v_mfma_f32_16x16x32_bf16 v[132:135], v[84:87], v[96:99], v[132:135]
ds_read_b128 v[48:51], v6 offset:0
v_mfma_f32_16x16x32_bf16 v[140:143], v[92:95], v[96:99], v[140:143]
ds_read_b64_tr_b16 v[40:41], v8 offset:40960
v_mfma_f32_16x16x32_bf16 v[144:147], v[80:83], v[100:103], v[144:147]
ds_read_b64_tr_b16 v[42:43], v8 offset:41472
v_mfma_f32_16x16x32_bf16 v[152:155], v[88:91], v[100:103], v[152:155]
ds_read_b64_tr_b16 v[36:37], v9 offset:32768
v_mfma_f32_16x16x32_bf16 v[148:151], v[84:87], v[100:103], v[148:151]
ds_read_b64_tr_b16 v[38:39], v9 offset:33280
v_mfma_f32_16x16x32_bf16 v[156:159], v[92:95], v[100:103], v[156:159]
ds_read_b64_tr_b16 v[44:45], v9 offset:40960
v_mfma_f32_16x16x32_bf16 v[160:163], v[80:83], v[104:107], v[160:163]
ds_read_b64_tr_b16 v[46:47], v9 offset:41472
v_mfma_f32_16x16x32_bf16 v[168:171], v[88:91], v[104:107], v[168:171]
ds_read_b128 v[52:55], v6 offset:2048
v_mfma_f32_16x16x32_bf16 v[164:167], v[84:87], v[104:107], v[164:167]
ds_read_b128 v[56:59], v6 offset:4096
v_mfma_f32_16x16x32_bf16 v[172:175], v[92:95], v[104:107], v[172:175]
ds_read_b128 v[60:63], v6 offset:6144
v_mfma_f32_16x16x32_bf16 v[176:179], v[80:83], v[108:111], v[176:179]
ds_read_b128 v[64:67], v6 offset:8192
v_mfma_f32_16x16x32_bf16 v[184:187], v[88:91], v[108:111], v[184:187]
ds_read_b128 v[68:71], v6 offset:10240
v_mfma_f32_16x16x32_bf16 v[180:183], v[84:87], v[108:111], v[180:183]
ds_read_b128 v[72:75], v6 offset:12288
v_mfma_f32_16x16x32_bf16 v[188:191], v[92:95], v[108:111], v[188:191]
ds_read_b128 v[76:79], v6 offset:14336
v_mfma_f32_16x16x32_bf16 v[192:195], v[80:83], v[112:115], v[192:195]
v_mfma_f32_16x16x32_bf16 v[200:203], v[88:91], v[112:115], v[200:203]
v_mfma_f32_16x16x32_bf16 v[196:199], v[84:87], v[112:115], v[196:199]
v_mfma_f32_16x16x32_bf16 v[204:207], v[92:95], v[112:115], v[204:207]
v_mfma_f32_16x16x32_bf16 v[208:211], v[80:83], v[116:119], v[208:211]
v_mfma_f32_16x16x32_bf16 v[216:219], v[88:91], v[116:119], v[216:219]
v_mfma_f32_16x16x32_bf16 v[212:215], v[84:87], v[116:119], v[212:215]
v_mfma_f32_16x16x32_bf16 v[220:223], v[92:95], v[116:119], v[220:223]
v_mfma_f32_16x16x32_bf16 v[224:227], v[80:83], v[120:123], v[224:227]
v_mfma_f32_16x16x32_bf16 v[232:235], v[88:91], v[120:123], v[232:235]
v_mfma_f32_16x16x32_bf16 v[228:231], v[84:87], v[120:123], v[228:231]
v_mfma_f32_16x16x32_bf16 v[236:239], v[92:95], v[120:123], v[236:239]
v_mfma_f32_16x16x32_bf16 v[240:243], v[80:83], v[124:127], v[240:243]
v_mfma_f32_16x16x32_bf16 v[248:251], v[88:91], v[124:127], v[248:251]
v_mfma_f32_16x16x32_bf16 v[244:247], v[84:87], v[124:127], v[244:247]
v_mfma_f32_16x16x32_bf16 v[252:255], v[92:95], v[124:127], v[252:255]
s_waitcnt lgkmcnt(0)
v_mfma_f32_16x16x32_bf16 v[128:131], v[32:35], v[48:51], v[128:131]
ds_read_b64_tr_b16 v[80:81], v8 offset:36864
v_mfma_f32_16x16x32_bf16 v[136:139], v[40:43], v[48:51], v[136:139]
ds_read_b64_tr_b16 v[82:83], v8 offset:37376
v_mfma_f32_16x16x32_bf16 v[132:135], v[36:39], v[48:51], v[132:135]
ds_read_b128 v[96:99], v7 offset:0
v_mfma_f32_16x16x32_bf16 v[140:143], v[44:47], v[48:51], v[140:143]
ds_read_b64_tr_b16 v[88:89], v8 offset:45056
v_mfma_f32_16x16x32_bf16 v[144:147], v[32:35], v[52:55], v[144:147]
ds_read_b64_tr_b16 v[90:91], v8 offset:45568
v_mfma_f32_16x16x32_bf16 v[152:155], v[40:43], v[52:55], v[152:155]
ds_read_b64_tr_b16 v[84:85], v9 offset:36864
v_mfma_f32_16x16x32_bf16 v[148:151], v[36:39], v[52:55], v[148:151]
ds_read_b64_tr_b16 v[86:87], v9 offset:37376
v_mfma_f32_16x16x32_bf16 v[156:159], v[44:47], v[52:55], v[156:159]
ds_read_b64_tr_b16 v[92:93], v9 offset:45056
v_mfma_f32_16x16x32_bf16 v[160:163], v[32:35], v[56:59], v[160:163]
ds_read_b64_tr_b16 v[94:95], v9 offset:45568
v_mfma_f32_16x16x32_bf16 v[168:171], v[40:43], v[56:59], v[168:171]
ds_read_b128 v[100:103], v7 offset:2048
v_mfma_f32_16x16x32_bf16 v[164:167], v[36:39], v[56:59], v[164:167]
ds_read_b128 v[104:107], v7 offset:4096
v_mfma_f32_16x16x32_bf16 v[172:175], v[44:47], v[56:59], v[172:175]
ds_read_b128 v[108:111], v7 offset:6144
v_mfma_f32_16x16x32_bf16 v[176:179], v[32:35], v[60:63], v[176:179]
ds_read_b128 v[112:115], v7 offset:8192
v_mfma_f32_16x16x32_bf16 v[184:187], v[40:43], v[60:63], v[184:187]
ds_read_b128 v[116:119], v7 offset:10240
v_mfma_f32_16x16x32_bf16 v[180:183], v[36:39], v[60:63], v[180:183]
ds_read_b128 v[120:123], v7 offset:12288
v_mfma_f32_16x16x32_bf16 v[188:191], v[44:47], v[60:63], v[188:191]
ds_read_b128 v[124:127], v7 offset:14336
v_mfma_f32_16x16x32_bf16 v[192:195], v[32:35], v[64:67], v[192:195]
v_mfma_f32_16x16x32_bf16 v[200:203], v[40:43], v[64:67], v[200:203]
v_mfma_f32_16x16x32_bf16 v[196:199], v[36:39], v[64:67], v[196:199]
v_mfma_f32_16x16x32_bf16 v[204:207], v[44:47], v[64:67], v[204:207]
v_mfma_f32_16x16x32_bf16 v[208:211], v[32:35], v[68:71], v[208:211]
v_mfma_f32_16x16x32_bf16 v[216:219], v[40:43], v[68:71], v[216:219]
v_mfma_f32_16x16x32_bf16 v[212:215], v[36:39], v[68:71], v[212:215]
v_mfma_f32_16x16x32_bf16 v[220:223], v[44:47], v[68:71], v[220:223]
v_mfma_f32_16x16x32_bf16 v[224:227], v[32:35], v[72:75], v[224:227]
v_mfma_f32_16x16x32_bf16 v[232:235], v[40:43], v[72:75], v[232:235]
v_mfma_f32_16x16x32_bf16 v[228:231], v[36:39], v[72:75], v[228:231]
v_mfma_f32_16x16x32_bf16 v[236:239], v[44:47], v[72:75], v[236:239]
v_mfma_f32_16x16x32_bf16 v[240:243], v[32:35], v[76:79], v[240:243]
v_mfma_f32_16x16x32_bf16 v[248:251], v[40:43], v[76:79], v[248:251]
v_mfma_f32_16x16x32_bf16 v[244:247], v[36:39], v[76:79], v[244:247]
v_mfma_f32_16x16x32_bf16 v[252:255], v[44:47], v[76:79], v[252:255]
s_waitcnt lgkmcnt(0)
s_barrier
v_mfma_f32_16x16x32_bf16 v[128:131], v[80:83], v[96:99], v[128:131]
ds_read_b64_tr_b16 v[32:33], v8 offset:0
v_mfma_f32_16x16x32_bf16 v[136:139], v[88:91], v[96:99], v[136:139]
ds_read_b64_tr_b16 v[34:35], v8 offset:512
v_mfma_f32_16x16x32_bf16 v[132:135], v[84:87], v[96:99], v[132:135]
ds_read_b128 v[48:51], v4 offset:0
v_mfma_f32_16x16x32_bf16 v[140:143], v[92:95], v[96:99], v[140:143]
ds_read_b64_tr_b16 v[40:41], v8 offset:8192
v_mfma_f32_16x16x32_bf16 v[144:147], v[80:83], v[100:103], v[144:147]
ds_read_b64_tr_b16 v[42:43], v8 offset:8704
v_mfma_f32_16x16x32_bf16 v[152:155], v[88:91], v[100:103], v[152:155]
ds_read_b64_tr_b16 v[36:37], v9 offset:0
v_mfma_f32_16x16x32_bf16 v[148:151], v[84:87], v[100:103], v[148:151]
ds_read_b64_tr_b16 v[38:39], v9 offset:512
v_mfma_f32_16x16x32_bf16 v[156:159], v[92:95], v[100:103], v[156:159]
ds_read_b64_tr_b16 v[44:45], v9 offset:8192
v_mfma_f32_16x16x32_bf16 v[160:163], v[80:83], v[104:107], v[160:163]
ds_read_b64_tr_b16 v[46:47], v9 offset:8704
v_mfma_f32_16x16x32_bf16 v[168:171], v[88:91], v[104:107], v[168:171]
ds_read_b128 v[52:55], v4 offset:2048
v_mfma_f32_16x16x32_bf16 v[164:167], v[84:87], v[104:107], v[164:167]
ds_read_b128 v[56:59], v4 offset:4096
v_mfma_f32_16x16x32_bf16 v[172:175], v[92:95], v[104:107], v[172:175]
ds_read_b128 v[60:63], v4 offset:6144
v_mfma_f32_16x16x32_bf16 v[176:179], v[80:83], v[108:111], v[176:179]
ds_read_b128 v[64:67], v4 offset:8192
v_mfma_f32_16x16x32_bf16 v[184:187], v[88:91], v[108:111], v[184:187]
ds_read_b128 v[68:71], v4 offset:10240
v_mfma_f32_16x16x32_bf16 v[180:183], v[84:87], v[108:111], v[180:183]
ds_read_b128 v[72:75], v4 offset:12288
v_mfma_f32_16x16x32_bf16 v[188:191], v[92:95], v[108:111], v[188:191]
ds_read_b128 v[76:79], v4 offset:14336
v_mfma_f32_16x16x32_bf16 v[192:195], v[80:83], v[112:115], v[192:195]
v_mfma_f32_16x16x32_bf16 v[200:203], v[88:91], v[112:115], v[200:203]
v_mfma_f32_16x16x32_bf16 v[196:199], v[84:87], v[112:115], v[196:199]
v_mfma_f32_16x16x32_bf16 v[204:207], v[92:95], v[112:115], v[204:207]
v_mfma_f32_16x16x32_bf16 v[208:211], v[80:83], v[116:119], v[208:211]
v_mfma_f32_16x16x32_bf16 v[216:219], v[88:91], v[116:119], v[216:219]
v_mfma_f32_16x16x32_bf16 v[212:215], v[84:87], v[116:119], v[212:215]
v_mfma_f32_16x16x32_bf16 v[220:223], v[92:95], v[116:119], v[220:223]
v_mfma_f32_16x16x32_bf16 v[224:227], v[80:83], v[120:123], v[224:227]
v_mfma_f32_16x16x32_bf16 v[232:235], v[88:91], v[120:123], v[232:235]
v_mfma_f32_16x16x32_bf16 v[228:231], v[84:87], v[120:123], v[228:231]
v_mfma_f32_16x16x32_bf16 v[236:239], v[92:95], v[120:123], v[236:239]
v_mfma_f32_16x16x32_bf16 v[240:243], v[80:83], v[124:127], v[240:243]
v_mfma_f32_16x16x32_bf16 v[248:251], v[88:91], v[124:127], v[248:251]
v_mfma_f32_16x16x32_bf16 v[244:247], v[84:87], v[124:127], v[244:247]
v_mfma_f32_16x16x32_bf16 v[252:255], v[92:95], v[124:127], v[252:255]
s_waitcnt lgkmcnt(0)
v_mfma_f32_16x16x32_bf16 v[128:131], v[32:35], v[48:51], v[128:131]
ds_read_b64_tr_b16 v[80:81], v8 offset:4096
v_mfma_f32_16x16x32_bf16 v[136:139], v[40:43], v[48:51], v[136:139]
ds_read_b64_tr_b16 v[82:83], v8 offset:4608
v_mfma_f32_16x16x32_bf16 v[132:135], v[36:39], v[48:51], v[132:135]
ds_read_b128 v[96:99], v5 offset:0
v_mfma_f32_16x16x32_bf16 v[140:143], v[44:47], v[48:51], v[140:143]
ds_read_b64_tr_b16 v[88:89], v8 offset:12288
v_mfma_f32_16x16x32_bf16 v[144:147], v[32:35], v[52:55], v[144:147]
ds_read_b64_tr_b16 v[90:91], v8 offset:12800
v_mfma_f32_16x16x32_bf16 v[152:155], v[40:43], v[52:55], v[152:155]
ds_read_b64_tr_b16 v[84:85], v9 offset:4096
v_mfma_f32_16x16x32_bf16 v[148:151], v[36:39], v[52:55], v[148:151]
ds_read_b64_tr_b16 v[86:87], v9 offset:4608
v_mfma_f32_16x16x32_bf16 v[156:159], v[44:47], v[52:55], v[156:159]
ds_read_b64_tr_b16 v[92:93], v9 offset:12288
v_mfma_f32_16x16x32_bf16 v[160:163], v[32:35], v[56:59], v[160:163]
ds_read_b64_tr_b16 v[94:95], v9 offset:12800
v_mfma_f32_16x16x32_bf16 v[168:171], v[40:43], v[56:59], v[168:171]
ds_read_b128 v[100:103], v5 offset:2048
v_mfma_f32_16x16x32_bf16 v[164:167], v[36:39], v[56:59], v[164:167]
ds_read_b128 v[104:107], v5 offset:4096
v_mfma_f32_16x16x32_bf16 v[172:175], v[44:47], v[56:59], v[172:175]
ds_read_b128 v[108:111], v5 offset:6144
v_mfma_f32_16x16x32_bf16 v[176:179], v[32:35], v[60:63], v[176:179]
ds_read_b128 v[112:115], v5 offset:8192
v_mfma_f32_16x16x32_bf16 v[184:187], v[40:43], v[60:63], v[184:187]
ds_read_b128 v[116:119], v5 offset:10240
v_mfma_f32_16x16x32_bf16 v[180:183], v[36:39], v[60:63], v[180:183]
ds_read_b128 v[120:123], v5 offset:12288
v_mfma_f32_16x16x32_bf16 v[188:191], v[44:47], v[60:63], v[188:191]
ds_read_b128 v[124:127], v5 offset:14336
v_mfma_f32_16x16x32_bf16 v[192:195], v[32:35], v[64:67], v[192:195]
v_mfma_f32_16x16x32_bf16 v[200:203], v[40:43], v[64:67], v[200:203]
v_mfma_f32_16x16x32_bf16 v[196:199], v[36:39], v[64:67], v[196:199]
v_mfma_f32_16x16x32_bf16 v[204:207], v[44:47], v[64:67], v[204:207]
v_mfma_f32_16x16x32_bf16 v[208:211], v[32:35], v[68:71], v[208:211]
v_mfma_f32_16x16x32_bf16 v[216:219], v[40:43], v[68:71], v[216:219]
v_mfma_f32_16x16x32_bf16 v[212:215], v[36:39], v[68:71], v[212:215]
v_mfma_f32_16x16x32_bf16 v[220:223], v[44:47], v[68:71], v[220:223]
v_mfma_f32_16x16x32_bf16 v[224:227], v[32:35], v[72:75], v[224:227]
v_mfma_f32_16x16x32_bf16 v[232:235], v[40:43], v[72:75], v[232:235]
v_mfma_f32_16x16x32_bf16 v[228:231], v[36:39], v[72:75], v[228:231]
v_mfma_f32_16x16x32_bf16 v[236:239], v[44:47], v[72:75], v[236:239]
v_mfma_f32_16x16x32_bf16 v[240:243], v[32:35], v[76:79], v[240:243]
v_mfma_f32_16x16x32_bf16 v[248:251], v[40:43], v[76:79], v[248:251]
v_mfma_f32_16x16x32_bf16 v[244:247], v[36:39], v[76:79], v[244:247]
v_mfma_f32_16x16x32_bf16 v[252:255], v[44:47], v[76:79], v[252:255]
s_waitcnt lgkmcnt(0)
s_barrier
v_mfma_f32_16x16x32_bf16 v[128:131], v[80:83], v[96:99], v[128:131]
ds_read_b64_tr_b16 v[32:33], v8 offset:16384
v_mfma_f32_16x16x32_bf16 v[136:139], v[88:91], v[96:99], v[136:139]
ds_read_b64_tr_b16 v[34:35], v8 offset:16896
v_mfma_f32_16x16x32_bf16 v[132:135], v[84:87], v[96:99], v[132:135]
ds_read_b128 v[48:51], v4 offset:32768
v_mfma_f32_16x16x32_bf16 v[140:143], v[92:95], v[96:99], v[140:143]
ds_read_b64_tr_b16 v[40:41], v8 offset:24576
v_mfma_f32_16x16x32_bf16 v[144:147], v[80:83], v[100:103], v[144:147]
ds_read_b64_tr_b16 v[42:43], v8 offset:25088
v_mfma_f32_16x16x32_bf16 v[152:155], v[88:91], v[100:103], v[152:155]
ds_read_b64_tr_b16 v[36:37], v9 offset:16384
v_mfma_f32_16x16x32_bf16 v[148:151], v[84:87], v[100:103], v[148:151]
ds_read_b64_tr_b16 v[38:39], v9 offset:16896
v_mfma_f32_16x16x32_bf16 v[156:159], v[92:95], v[100:103], v[156:159]
ds_read_b64_tr_b16 v[44:45], v9 offset:24576
v_mfma_f32_16x16x32_bf16 v[160:163], v[80:83], v[104:107], v[160:163]
ds_read_b64_tr_b16 v[46:47], v9 offset:25088
v_mfma_f32_16x16x32_bf16 v[168:171], v[88:91], v[104:107], v[168:171]
ds_read_b128 v[52:55], v4 offset:34816
v_mfma_f32_16x16x32_bf16 v[164:167], v[84:87], v[104:107], v[164:167]
ds_read_b128 v[56:59], v4 offset:36864
v_mfma_f32_16x16x32_bf16 v[172:175], v[92:95], v[104:107], v[172:175]
ds_read_b128 v[60:63], v4 offset:38912
v_mfma_f32_16x16x32_bf16 v[176:179], v[80:83], v[108:111], v[176:179]
ds_read_b128 v[64:67], v4 offset:40960
v_mfma_f32_16x16x32_bf16 v[184:187], v[88:91], v[108:111], v[184:187]
ds_read_b128 v[68:71], v4 offset:43008
v_mfma_f32_16x16x32_bf16 v[180:183], v[84:87], v[108:111], v[180:183]
ds_read_b128 v[72:75], v4 offset:45056
v_mfma_f32_16x16x32_bf16 v[188:191], v[92:95], v[108:111], v[188:191]
ds_read_b128 v[76:79], v4 offset:47104
v_mfma_f32_16x16x32_bf16 v[192:195], v[80:83], v[112:115], v[192:195]
v_mfma_f32_16x16x32_bf16 v[200:203], v[88:91], v[112:115], v[200:203]
v_mfma_f32_16x16x32_bf16 v[196:199], v[84:87], v[112:115], v[196:199]
v_mfma_f32_16x16x32_bf16 v[204:207], v[92:95], v[112:115], v[204:207]
v_mfma_f32_16x16x32_bf16 v[208:211], v[80:83], v[116:119], v[208:211]
v_mfma_f32_16x16x32_bf16 v[216:219], v[88:91], v[116:119], v[216:219]
v_mfma_f32_16x16x32_bf16 v[212:215], v[84:87], v[116:119], v[212:215]
v_mfma_f32_16x16x32_bf16 v[220:223], v[92:95], v[116:119], v[220:223]
v_mfma_f32_16x16x32_bf16 v[224:227], v[80:83], v[120:123], v[224:227]
v_mfma_f32_16x16x32_bf16 v[232:235], v[88:91], v[120:123], v[232:235]
v_mfma_f32_16x16x32_bf16 v[228:231], v[84:87], v[120:123], v[228:231]
v_mfma_f32_16x16x32_bf16 v[236:239], v[92:95], v[120:123], v[236:239]
v_mfma_f32_16x16x32_bf16 v[240:243], v[80:83], v[124:127], v[240:243]
v_mfma_f32_16x16x32_bf16 v[248:251], v[88:91], v[124:127], v[248:251]
v_mfma_f32_16x16x32_bf16 v[244:247], v[84:87], v[124:127], v[244:247]
v_mfma_f32_16x16x32_bf16 v[252:255], v[92:95], v[124:127], v[252:255]
s_waitcnt lgkmcnt(0)
v_mfma_f32_16x16x32_bf16 v[128:131], v[32:35], v[48:51], v[128:131]
ds_read_b64_tr_b16 v[80:81], v8 offset:20480
v_mfma_f32_16x16x32_bf16 v[136:139], v[40:43], v[48:51], v[136:139]
ds_read_b64_tr_b16 v[82:83], v8 offset:20992
v_mfma_f32_16x16x32_bf16 v[132:135], v[36:39], v[48:51], v[132:135]
ds_read_b128 v[96:99], v5 offset:32768
v_mfma_f32_16x16x32_bf16 v[140:143], v[44:47], v[48:51], v[140:143]
ds_read_b64_tr_b16 v[88:89], v8 offset:28672
v_mfma_f32_16x16x32_bf16 v[144:147], v[32:35], v[52:55], v[144:147]
ds_read_b64_tr_b16 v[90:91], v8 offset:29184
v_mfma_f32_16x16x32_bf16 v[152:155], v[40:43], v[52:55], v[152:155]
ds_read_b64_tr_b16 v[84:85], v9 offset:20480
v_mfma_f32_16x16x32_bf16 v[148:151], v[36:39], v[52:55], v[148:151]
ds_read_b64_tr_b16 v[86:87], v9 offset:20992
v_mfma_f32_16x16x32_bf16 v[156:159], v[44:47], v[52:55], v[156:159]
ds_read_b64_tr_b16 v[92:93], v9 offset:28672
v_mfma_f32_16x16x32_bf16 v[160:163], v[32:35], v[56:59], v[160:163]
ds_read_b64_tr_b16 v[94:95], v9 offset:29184
v_mfma_f32_16x16x32_bf16 v[168:171], v[40:43], v[56:59], v[168:171]
ds_read_b128 v[100:103], v5 offset:34816
v_mfma_f32_16x16x32_bf16 v[164:167], v[36:39], v[56:59], v[164:167]
ds_read_b128 v[104:107], v5 offset:36864
v_mfma_f32_16x16x32_bf16 v[172:175], v[44:47], v[56:59], v[172:175]
ds_read_b128 v[108:111], v5 offset:38912
v_mfma_f32_16x16x32_bf16 v[176:179], v[32:35], v[60:63], v[176:179]
ds_read_b128 v[112:115], v5 offset:40960
v_mfma_f32_16x16x32_bf16 v[184:187], v[40:43], v[60:63], v[184:187]
ds_read_b128 v[116:119], v5 offset:43008
v_mfma_f32_16x16x32_bf16 v[180:183], v[36:39], v[60:63], v[180:183]
ds_read_b128 v[120:123], v5 offset:45056
v_mfma_f32_16x16x32_bf16 v[188:191], v[44:47], v[60:63], v[188:191]
ds_read_b128 v[124:127], v5 offset:47104
v_mfma_f32_16x16x32_bf16 v[192:195], v[32:35], v[64:67], v[192:195]
v_mfma_f32_16x16x32_bf16 v[200:203], v[40:43], v[64:67], v[200:203]
v_mfma_f32_16x16x32_bf16 v[196:199], v[36:39], v[64:67], v[196:199]
v_mfma_f32_16x16x32_bf16 v[204:207], v[44:47], v[64:67], v[204:207]
v_mfma_f32_16x16x32_bf16 v[208:211], v[32:35], v[68:71], v[208:211]
v_mfma_f32_16x16x32_bf16 v[216:219], v[40:43], v[68:71], v[216:219]
v_mfma_f32_16x16x32_bf16 v[212:215], v[36:39], v[68:71], v[212:215]
v_mfma_f32_16x16x32_bf16 v[220:223], v[44:47], v[68:71], v[220:223]
v_mfma_f32_16x16x32_bf16 v[224:227], v[32:35], v[72:75], v[224:227]
v_mfma_f32_16x16x32_bf16 v[232:235], v[40:43], v[72:75], v[232:235]
v_mfma_f32_16x16x32_bf16 v[228:231], v[36:39], v[72:75], v[228:231]
v_mfma_f32_16x16x32_bf16 v[236:239], v[44:47], v[72:75], v[236:239]
v_mfma_f32_16x16x32_bf16 v[240:243], v[32:35], v[76:79], v[240:243]
v_mfma_f32_16x16x32_bf16 v[248:251], v[40:43], v[76:79], v[248:251]
v_mfma_f32_16x16x32_bf16 v[244:247], v[36:39], v[76:79], v[244:247]
v_mfma_f32_16x16x32_bf16 v[252:255], v[44:47], v[76:79], v[252:255]
s_waitcnt lgkmcnt(0)
s_barrier
v_mfma_f32_16x16x32_bf16 v[128:131], v[80:83], v[96:99], v[128:131]
ds_read_b64_tr_b16 v[32:33], v8 offset:32768
v_mfma_f32_16x16x32_bf16 v[136:139], v[88:91], v[96:99], v[136:139]
ds_read_b64_tr_b16 v[34:35], v8 offset:33280
v_mfma_f32_16x16x32_bf16 v[132:135], v[84:87], v[96:99], v[132:135]
ds_read_b128 v[48:51], v6 offset:0
v_mfma_f32_16x16x32_bf16 v[140:143], v[92:95], v[96:99], v[140:143]
ds_read_b64_tr_b16 v[40:41], v8 offset:40960
v_mfma_f32_16x16x32_bf16 v[144:147], v[80:83], v[100:103], v[144:147]
ds_read_b64_tr_b16 v[42:43], v8 offset:41472
v_mfma_f32_16x16x32_bf16 v[152:155], v[88:91], v[100:103], v[152:155]
ds_read_b64_tr_b16 v[36:37], v9 offset:32768
v_mfma_f32_16x16x32_bf16 v[148:151], v[84:87], v[100:103], v[148:151]
ds_read_b64_tr_b16 v[38:39], v9 offset:33280
v_mfma_f32_16x16x32_bf16 v[156:159], v[92:95], v[100:103], v[156:159]
ds_read_b64_tr_b16 v[44:45], v9 offset:40960
v_mfma_f32_16x16x32_bf16 v[160:163], v[80:83], v[104:107], v[160:163]
ds_read_b64_tr_b16 v[46:47], v9 offset:41472
v_mfma_f32_16x16x32_bf16 v[168:171], v[88:91], v[104:107], v[168:171]
ds_read_b128 v[52:55], v6 offset:2048
v_mfma_f32_16x16x32_bf16 v[164:167], v[84:87], v[104:107], v[164:167]
ds_read_b128 v[56:59], v6 offset:4096
v_mfma_f32_16x16x32_bf16 v[172:175], v[92:95], v[104:107], v[172:175]
ds_read_b128 v[60:63], v6 offset:6144
v_mfma_f32_16x16x32_bf16 v[176:179], v[80:83], v[108:111], v[176:179]
ds_read_b128 v[64:67], v6 offset:8192
v_mfma_f32_16x16x32_bf16 v[184:187], v[88:91], v[108:111], v[184:187]
ds_read_b128 v[68:71], v6 offset:10240
v_mfma_f32_16x16x32_bf16 v[180:183], v[84:87], v[108:111], v[180:183]
ds_read_b128 v[72:75], v6 offset:12288
v_mfma_f32_16x16x32_bf16 v[188:191], v[92:95], v[108:111], v[188:191]
ds_read_b128 v[76:79], v6 offset:14336
v_mfma_f32_16x16x32_bf16 v[192:195], v[80:83], v[112:115], v[192:195]
v_mfma_f32_16x16x32_bf16 v[200:203], v[88:91], v[112:115], v[200:203]
v_mfma_f32_16x16x32_bf16 v[196:199], v[84:87], v[112:115], v[196:199]
v_mfma_f32_16x16x32_bf16 v[204:207], v[92:95], v[112:115], v[204:207]
v_mfma_f32_16x16x32_bf16 v[208:211], v[80:83], v[116:119], v[208:211]
v_mfma_f32_16x16x32_bf16 v[216:219], v[88:91], v[116:119], v[216:219]
v_mfma_f32_16x16x32_bf16 v[212:215], v[84:87], v[116:119], v[212:215]
v_mfma_f32_16x16x32_bf16 v[220:223], v[92:95], v[116:119], v[220:223]
v_mfma_f32_16x16x32_bf16 v[224:227], v[80:83], v[120:123], v[224:227]
v_mfma_f32_16x16x32_bf16 v[232:235], v[88:91], v[120:123], v[232:235]
v_mfma_f32_16x16x32_bf16 v[228:231], v[84:87], v[120:123], v[228:231]
v_mfma_f32_16x16x32_bf16 v[236:239], v[92:95], v[120:123], v[236:239]
v_mfma_f32_16x16x32_bf16 v[240:243], v[80:83], v[124:127], v[240:243]
v_mfma_f32_16x16x32_bf16 v[248:251], v[88:91], v[124:127], v[248:251]
v_mfma_f32_16x16x32_bf16 v[244:247], v[84:87], v[124:127], v[244:247]
v_mfma_f32_16x16x32_bf16 v[252:255], v[92:95], v[124:127], v[252:255]
s_waitcnt lgkmcnt(0)
v_mfma_f32_16x16x32_bf16 v[128:131], v[32:35], v[48:51], v[128:131]
ds_read_b64_tr_b16 v[80:81], v8 offset:36864
v_mfma_f32_16x16x32_bf16 v[136:139], v[40:43], v[48:51], v[136:139]
ds_read_b64_tr_b16 v[82:83], v8 offset:37376
v_mfma_f32_16x16x32_bf16 v[132:135], v[36:39], v[48:51], v[132:135]
ds_read_b128 v[96:99], v7 offset:0
v_mfma_f32_16x16x32_bf16 v[140:143], v[44:47], v[48:51], v[140:143]
ds_read_b64_tr_b16 v[88:89], v8 offset:45056
v_mfma_f32_16x16x32_bf16 v[144:147], v[32:35], v[52:55], v[144:147]
ds_read_b64_tr_b16 v[90:91], v8 offset:45568
v_mfma_f32_16x16x32_bf16 v[152:155], v[40:43], v[52:55], v[152:155]
ds_read_b64_tr_b16 v[84:85], v9 offset:36864
v_mfma_f32_16x16x32_bf16 v[148:151], v[36:39], v[52:55], v[148:151]
ds_read_b64_tr_b16 v[86:87], v9 offset:37376
v_mfma_f32_16x16x32_bf16 v[156:159], v[44:47], v[52:55], v[156:159]
ds_read_b64_tr_b16 v[92:93], v9 offset:45056
v_mfma_f32_16x16x32_bf16 v[160:163], v[32:35], v[56:59], v[160:163]
ds_read_b64_tr_b16 v[94:95], v9 offset:45568
v_mfma_f32_16x16x32_bf16 v[168:171], v[40:43], v[56:59], v[168:171]
ds_read_b128 v[100:103], v7 offset:2048
v_mfma_f32_16x16x32_bf16 v[164:167], v[36:39], v[56:59], v[164:167]
ds_read_b128 v[104:107], v7 offset:4096
v_mfma_f32_16x16x32_bf16 v[172:175], v[44:47], v[56:59], v[172:175]
ds_read_b128 v[108:111], v7 offset:6144
v_mfma_f32_16x16x32_bf16 v[176:179], v[32:35], v[60:63], v[176:179]
ds_read_b128 v[112:115], v7 offset:8192
v_mfma_f32_16x16x32_bf16 v[184:187], v[40:43], v[60:63], v[184:187]
ds_read_b128 v[116:119], v7 offset:10240
v_mfma_f32_16x16x32_bf16 v[180:183], v[36:39], v[60:63], v[180:183]
ds_read_b128 v[120:123], v7 offset:12288
v_mfma_f32_16x16x32_bf16 v[188:191], v[44:47], v[60:63], v[188:191]
ds_read_b128 v[124:127], v7 offset:14336
v_mfma_f32_16x16x32_bf16 v[192:195], v[32:35], v[64:67], v[192:195]
v_mfma_f32_16x16x32_bf16 v[200:203], v[40:43], v[64:67], v[200:203]
v_mfma_f32_16x16x32_bf16 v[196:199], v[36:39], v[64:67], v[196:199]
v_mfma_f32_16x16x32_bf16 v[204:207], v[44:47], v[64:67], v[204:207]
v_mfma_f32_16x16x32_bf16 v[208:211], v[32:35], v[68:71], v[208:211]
v_mfma_f32_16x16x32_bf16 v[216:219], v[40:43], v[68:71], v[216:219]
v_mfma_f32_16x16x32_bf16 v[212:215], v[36:39], v[68:71], v[212:215]
v_mfma_f32_16x16x32_bf16 v[220:223], v[44:47], v[68:71], v[220:223]
v_mfma_f32_16x16x32_bf16 v[224:227], v[32:35], v[72:75], v[224:227]
v_mfma_f32_16x16x32_bf16 v[232:235], v[40:43], v[72:75], v[232:235]
v_mfma_f32_16x16x32_bf16 v[228:231], v[36:39], v[72:75], v[228:231]
v_mfma_f32_16x16x32_bf16 v[236:239], v[44:47], v[72:75], v[236:239]
v_mfma_f32_16x16x32_bf16 v[240:243], v[32:35], v[76:79], v[240:243]
v_mfma_f32_16x16x32_bf16 v[248:251], v[40:43], v[76:79], v[248:251]
v_mfma_f32_16x16x32_bf16 v[244:247], v[36:39], v[76:79], v[244:247]
v_mfma_f32_16x16x32_bf16 v[252:255], v[44:47], v[76:79], v[252:255]
s_waitcnt lgkmcnt(0)
s_barrier
v_mfma_f32_16x16x32_bf16 v[128:131], v[80:83], v[96:99], v[128:131]
ds_read_b64_tr_b16 v[32:33], v8 offset:0
v_mfma_f32_16x16x32_bf16 v[136:139], v[88:91], v[96:99], v[136:139]
ds_read_b64_tr_b16 v[34:35], v8 offset:512
v_mfma_f32_16x16x32_bf16 v[132:135], v[84:87], v[96:99], v[132:135]
ds_read_b128 v[48:51], v4 offset:0
v_mfma_f32_16x16x32_bf16 v[140:143], v[92:95], v[96:99], v[140:143]
ds_read_b64_tr_b16 v[40:41], v8 offset:8192
v_mfma_f32_16x16x32_bf16 v[144:147], v[80:83], v[100:103], v[144:147]
ds_read_b64_tr_b16 v[42:43], v8 offset:8704
v_mfma_f32_16x16x32_bf16 v[152:155], v[88:91], v[100:103], v[152:155]
ds_read_b64_tr_b16 v[36:37], v9 offset:0
v_mfma_f32_16x16x32_bf16 v[148:151], v[84:87], v[100:103], v[148:151]
ds_read_b64_tr_b16 v[38:39], v9 offset:512
v_mfma_f32_16x16x32_bf16 v[156:159], v[92:95], v[100:103], v[156:159]
ds_read_b64_tr_b16 v[44:45], v9 offset:8192
v_mfma_f32_16x16x32_bf16 v[160:163], v[80:83], v[104:107], v[160:163]
ds_read_b64_tr_b16 v[46:47], v9 offset:8704
v_mfma_f32_16x16x32_bf16 v[168:171], v[88:91], v[104:107], v[168:171]
ds_read_b128 v[52:55], v4 offset:2048
v_mfma_f32_16x16x32_bf16 v[164:167], v[84:87], v[104:107], v[164:167]
ds_read_b128 v[56:59], v4 offset:4096
v_mfma_f32_16x16x32_bf16 v[172:175], v[92:95], v[104:107], v[172:175]
ds_read_b128 v[60:63], v4 offset:6144
v_mfma_f32_16x16x32_bf16 v[176:179], v[80:83], v[108:111], v[176:179]
ds_read_b128 v[64:67], v4 offset:8192
v_mfma_f32_16x16x32_bf16 v[184:187], v[88:91], v[108:111], v[184:187]
ds_read_b128 v[68:71], v4 offset:10240
v_mfma_f32_16x16x32_bf16 v[180:183], v[84:87], v[108:111], v[180:183]
ds_read_b128 v[72:75], v4 offset:12288
v_mfma_f32_16x16x32_bf16 v[188:191], v[92:95], v[108:111], v[188:191]
ds_read_b128 v[76:79], v4 offset:14336
v_mfma_f32_16x16x32_bf16 v[192:195], v[80:83], v[112:115], v[192:195]
v_mfma_f32_16x16x32_bf16 v[200:203], v[88:91], v[112:115], v[200:203]
v_mfma_f32_16x16x32_bf16 v[196:199], v[84:87], v[112:115], v[196:199]
v_mfma_f32_16x16x32_bf16 v[204:207], v[92:95], v[112:115], v[204:207]
v_mfma_f32_16x16x32_bf16 v[208:211], v[80:83], v[116:119], v[208:211]
v_mfma_f32_16x16x32_bf16 v[216:219], v[88:91], v[116:119], v[216:219]
v_mfma_f32_16x16x32_bf16 v[212:215], v[84:87], v[116:119], v[212:215]
v_mfma_f32_16x16x32_bf16 v[220:223], v[92:95], v[116:119], v[220:223]
v_mfma_f32_16x16x32_bf16 v[224:227], v[80:83], v[120:123], v[224:227]
v_mfma_f32_16x16x32_bf16 v[232:235], v[88:91], v[120:123], v[232:235]
v_mfma_f32_16x16x32_bf16 v[228:231], v[84:87], v[120:123], v[228:231]
v_mfma_f32_16x16x32_bf16 v[236:239], v[92:95], v[120:123], v[236:239]
v_mfma_f32_16x16x32_bf16 v[240:243], v[80:83], v[124:127], v[240:243]
v_mfma_f32_16x16x32_bf16 v[248:251], v[88:91], v[124:127], v[248:251]
v_mfma_f32_16x16x32_bf16 v[244:247], v[84:87], v[124:127], v[244:247]
v_mfma_f32_16x16x32_bf16 v[252:255], v[92:95], v[124:127], v[252:255]
s_waitcnt lgkmcnt(0)
v_mfma_f32_16x16x32_bf16 v[128:131], v[32:35], v[48:51], v[128:131]
ds_read_b64_tr_b16 v[80:81], v8 offset:4096
v_mfma_f32_16x16x32_bf16 v[136:139], v[40:43], v[48:51], v[136:139]
ds_read_b64_tr_b16 v[82:83], v8 offset:4608
v_mfma_f32_16x16x32_bf16 v[132:135], v[36:39], v[48:51], v[132:135]
ds_read_b128 v[96:99], v5 offset:0
v_mfma_f32_16x16x32_bf16 v[140:143], v[44:47], v[48:51], v[140:143]
ds_read_b64_tr_b16 v[88:89], v8 offset:12288
v_mfma_f32_16x16x32_bf16 v[144:147], v[32:35], v[52:55], v[144:147]
ds_read_b64_tr_b16 v[90:91], v8 offset:12800
v_mfma_f32_16x16x32_bf16 v[152:155], v[40:43], v[52:55], v[152:155]
ds_read_b64_tr_b16 v[84:85], v9 offset:4096
v_mfma_f32_16x16x32_bf16 v[148:151], v[36:39], v[52:55], v[148:151]
ds_read_b64_tr_b16 v[86:87], v9 offset:4608
v_mfma_f32_16x16x32_bf16 v[156:159], v[44:47], v[52:55], v[156:159]
ds_read_b64_tr_b16 v[92:93], v9 offset:12288
v_mfma_f32_16x16x32_bf16 v[160:163], v[32:35], v[56:59], v[160:163]
ds_read_b64_tr_b16 v[94:95], v9 offset:12800
v_mfma_f32_16x16x32_bf16 v[168:171], v[40:43], v[56:59], v[168:171]
ds_read_b128 v[100:103], v5 offset:2048
v_mfma_f32_16x16x32_bf16 v[164:167], v[36:39], v[56:59], v[164:167]
ds_read_b128 v[104:107], v5 offset:4096
v_mfma_f32_16x16x32_bf16 v[172:175], v[44:47], v[56:59], v[172:175]
ds_read_b128 v[108:111], v5 offset:6144
v_mfma_f32_16x16x32_bf16 v[176:179], v[32:35], v[60:63], v[176:179]
ds_read_b128 v[112:115], v5 offset:8192
v_mfma_f32_16x16x32_bf16 v[184:187], v[40:43], v[60:63], v[184:187]
ds_read_b128 v[116:119], v5 offset:10240
v_mfma_f32_16x16x32_bf16 v[180:183], v[36:39], v[60:63], v[180:183]
ds_read_b128 v[120:123], v5 offset:12288
v_mfma_f32_16x16x32_bf16 v[188:191], v[44:47], v[60:63], v[188:191]
ds_read_b128 v[124:127], v5 offset:14336
v_mfma_f32_16x16x32_bf16 v[192:195], v[32:35], v[64:67], v[192:195]
v_mfma_f32_16x16x32_bf16 v[200:203], v[40:43], v[64:67], v[200:203]
v_mfma_f32_16x16x32_bf16 v[196:199], v[36:39], v[64:67], v[196:199]
v_mfma_f32_16x16x32_bf16 v[204:207], v[44:47], v[64:67], v[204:207]
v_mfma_f32_16x16x32_bf16 v[208:211], v[32:35], v[68:71], v[208:211]
v_mfma_f32_16x16x32_bf16 v[216:219], v[40:43], v[68:71], v[216:219]
v_mfma_f32_16x16x32_bf16 v[212:215], v[36:39], v[68:71], v[212:215]
v_mfma_f32_16x16x32_bf16 v[220:223], v[44:47], v[68:71], v[220:223]
v_mfma_f32_16x16x32_bf16 v[224:227], v[32:35], v[72:75], v[224:227]
v_mfma_f32_16x16x32_bf16 v[232:235], v[40:43], v[72:75], v[232:235]
v_mfma_f32_16x16x32_bf16 v[228:231], v[36:39], v[72:75], v[228:231]
v_mfma_f32_16x16x32_bf16 v[236:239], v[44:47], v[72:75], v[236:239]
v_mfma_f32_16x16x32_bf16 v[240:243], v[32:35], v[76:79], v[240:243]
v_mfma_f32_16x16x32_bf16 v[248:251], v[40:43], v[76:79], v[248:251]
v_mfma_f32_16x16x32_bf16 v[244:247], v[36:39], v[76:79], v[244:247]
v_mfma_f32_16x16x32_bf16 v[252:255], v[44:47], v[76:79], v[252:255]
s_waitcnt lgkmcnt(0)
s_cmp_lg_u32 s3, 3
s_cbranch_scc1 standalone__swiglu_ffn__prompt_kernel_initok
s_waitcnt vmcnt(0)
v_min_u32 v17, v17, v18
s_nop 0
v_readfirstlane_b32 s64, v17
s_cmp_ge_u32 s64, 128
s_cbranch_scc1 standalone__swiglu_ffn__prompt_kernel_initok
s_mov_b32 s65, 400000
standalone__swiglu_ffn__prompt_kernel_ini_poll:
v_mov_b32 v17, 64
v_mov_b32 v18, 192
global_load_dword v17, v17, s[42:43] sc1
global_load_dword v18, v18, s[42:43] sc1
s_waitcnt vmcnt(0)
v_min_u32 v17, v17, v18
s_nop 0
v_readfirstlane_b32 s64, v17
s_cmp_ge_u32 s64, 128
s_cbranch_scc1 standalone__swiglu_ffn__prompt_kernel_ini_done
s_sub_u32 s65, s65, 1
s_cmp_lg_u32 s65, 0
s_cbranch_scc1 standalone__swiglu_ffn__prompt_kernel_ini_poll
standalone__swiglu_ffn__prompt_kernel_ini_done:
standalone__swiglu_ffn__prompt_kernel_initok:
s_barrier
v_mfma_f32_16x16x32_bf16 v[128:131], v[80:83], v[96:99], v[128:131]
v_mfma_f32_16x16x32_bf16 v[136:139], v[88:91], v[96:99], v[136:139]
v_mfma_f32_16x16x32_bf16 v[132:135], v[84:87], v[96:99], v[132:135]
v_mfma_f32_16x16x32_bf16 v[140:143], v[92:95], v[96:99], v[140:143]
v_mfma_f32_16x16x32_bf16 v[144:147], v[80:83], v[100:103], v[144:147]
v_mfma_f32_16x16x32_bf16 v[152:155], v[88:91], v[100:103], v[152:155]
v_mfma_f32_16x16x32_bf16 v[148:151], v[84:87], v[100:103], v[148:151]
v_mfma_f32_16x16x32_bf16 v[156:159], v[92:95], v[100:103], v[156:159]
v_mfma_f32_16x16x32_bf16 v[160:163], v[80:83], v[104:107], v[160:163]
v_mfma_f32_16x16x32_bf16 v[168:171], v[88:91], v[104:107], v[168:171]
v_mfma_f32_16x16x32_bf16 v[164:167], v[84:87], v[104:107], v[164:167]
v_mfma_f32_16x16x32_bf16 v[172:175], v[92:95], v[104:107], v[172:175]
v_mfma_f32_16x16x32_bf16 v[176:179], v[80:83], v[108:111], v[176:179]
v_mfma_f32_16x16x32_bf16 v[184:187], v[88:91], v[108:111], v[184:187]
v_mfma_f32_16x16x32_bf16 v[180:183], v[84:87], v[108:111], v[180:183]
v_mfma_f32_16x16x32_bf16 v[188:191], v[92:95], v[108:111], v[188:191]
v_mfma_f32_16x16x32_bf16 v[192:195], v[80:83], v[112:115], v[192:195]
v_mfma_f32_16x16x32_bf16 v[200:203], v[88:91], v[112:115], v[200:203]
v_mfma_f32_16x16x32_bf16 v[196:199], v[84:87], v[112:115], v[196:199]
v_mfma_f32_16x16x32_bf16 v[204:207], v[92:95], v[112:115], v[204:207]
v_mfma_f32_16x16x32_bf16 v[208:211], v[80:83], v[116:119], v[208:211]
v_mfma_f32_16x16x32_bf16 v[216:219], v[88:91], v[116:119], v[216:219]
v_mfma_f32_16x16x32_bf16 v[212:215], v[84:87], v[116:119], v[212:215]
v_mfma_f32_16x16x32_bf16 v[220:223], v[92:95], v[116:119], v[220:223]
v_mfma_f32_16x16x32_bf16 v[224:227], v[80:83], v[120:123], v[224:227]
v_mfma_f32_16x16x32_bf16 v[232:235], v[88:91], v[120:123], v[232:235]
v_mfma_f32_16x16x32_bf16 v[228:231], v[84:87], v[120:123], v[228:231]
v_mfma_f32_16x16x32_bf16 v[236:239], v[92:95], v[120:123], v[236:239]
v_mfma_f32_16x16x32_bf16 v[240:243], v[80:83], v[124:127], v[240:243]
v_mfma_f32_16x16x32_bf16 v[248:251], v[88:91], v[124:127], v[248:251]
v_mfma_f32_16x16x32_bf16 v[244:247], v[84:87], v[124:127], v[244:247]
v_mfma_f32_16x16x32_bf16 v[252:255], v[92:95], v[124:127], v[252:255]
s_mov_b32 s60, 3216550459
s_mov_b32 s61, 3216550459
s_nop 7
v_pk_mul_f32 v[32:33], v[128:129], s[60:61]
v_pk_mul_f32 v[34:35], v[130:131], s[60:61]
v_pk_mul_f32 v[36:37], v[132:133], s[60:61]
v_pk_mul_f32 v[38:39], v[134:135], s[60:61]
v_exp_f32 v32, v32
v_exp_f32 v33, v33
v_exp_f32 v34, v34
v_exp_f32 v35, v35
v_exp_f32 v36, v36
v_exp_f32 v37, v37
v_exp_f32 v38, v38
v_exp_f32 v39, v39
v_pk_mul_f32 v[136:137], v[128:129], v[136:137]
v_pk_mul_f32 v[138:139], v[130:131], v[138:139]
v_pk_mul_f32 v[140:141], v[132:133], v[140:141]
v_pk_mul_f32 v[142:143], v[134:135], v[142:143]
v_pk_add_f32 v[32:33], v[32:33], 1.0 op_sel_hi:[1,0]
v_pk_add_f32 v[34:35], v[34:35], 1.0 op_sel_hi:[1,0]
v_pk_add_f32 v[36:37], v[36:37], 1.0 op_sel_hi:[1,0]
v_pk_add_f32 v[38:39], v[38:39], 1.0 op_sel_hi:[1,0]
v_rcp_f32 v32, v32
v_rcp_f32 v33, v33
v_rcp_f32 v34, v34
v_rcp_f32 v35, v35
v_rcp_f32 v36, v36
v_rcp_f32 v37, v37
v_rcp_f32 v38, v38
v_rcp_f32 v39, v39
s_nop 0
v_pk_mul_f32 v[32:33], v[32:33], v[136:137]
v_pk_mul_f32 v[34:35], v[34:35], v[138:139]
v_pk_mul_f32 v[36:37], v[36:37], v[140:141]
v_pk_mul_f32 v[38:39], v[38:39], v[142:143]
v_cvt_pk_bf16_f32 v40, v32, v33
v_cvt_pk_bf16_f32 v41, v34, v35
v_cvt_pk_bf16_f32 v42, v36, v37
v_cvt_pk_bf16_f32 v43, v38, v39
s_add_u32 s58, s57, 0
buffer_store_dwordx4 v[40:43], v10, s[20:23], s58 offen sc1
v_pk_mul_f32 v[44:45], v[144:145], s[60:61]
v_pk_mul_f32 v[46:47], v[146:147], s[60:61]
v_pk_mul_f32 v[48:49], v[148:149], s[60:61]
v_pk_mul_f32 v[50:51], v[150:151], s[60:61]
v_exp_f32 v44, v44
v_exp_f32 v45, v45
v_exp_f32 v46, v46
v_exp_f32 v47, v47
v_exp_f32 v48, v48
v_exp_f32 v49, v49
v_exp_f32 v50, v50
v_exp_f32 v51, v51
v_pk_mul_f32 v[152:153], v[144:145], v[152:153]
v_pk_mul_f32 v[154:155], v[146:147], v[154:155]
v_pk_mul_f32 v[156:157], v[148:149], v[156:157]
v_pk_mul_f32 v[158:159], v[150:151], v[158:159]
v_pk_add_f32 v[44:45], v[44:45], 1.0 op_sel_hi:[1,0]
v_pk_add_f32 v[46:47], v[46:47], 1.0 op_sel_hi:[1,0]
v_pk_add_f32 v[48:49], v[48:49], 1.0 op_sel_hi:[1,0]
v_pk_add_f32 v[50:51], v[50:51], 1.0 op_sel_hi:[1,0]
v_rcp_f32 v44, v44
v_rcp_f32 v45, v45
v_rcp_f32 v46, v46
v_rcp_f32 v47, v47
v_rcp_f32 v48, v48
v_rcp_f32 v49, v49
v_rcp_f32 v50, v50
v_rcp_f32 v51, v51
s_nop 0
v_pk_mul_f32 v[44:45], v[44:45], v[152:153]
v_pk_mul_f32 v[46:47], v[46:47], v[154:155]
v_pk_mul_f32 v[48:49], v[48:49], v[156:157]
v_pk_mul_f32 v[50:51], v[50:51], v[158:159]
v_cvt_pk_bf16_f32 v52, v44, v45
v_cvt_pk_bf16_f32 v53, v46, v47
v_cvt_pk_bf16_f32 v54, v48, v49
v_cvt_pk_bf16_f32 v55, v50, v51
s_add_u32 s58, s57, 55296
buffer_store_dwordx4 v[52:55], v10, s[20:23], s58 offen sc1
v_pk_mul_f32 v[32:33], v[160:161], s[60:61]
v_pk_mul_f32 v[34:35], v[162:163], s[60:61]
v_pk_mul_f32 v[36:37], v[164:165], s[60:61]
v_pk_mul_f32 v[38:39], v[166:167], s[60:61]
v_exp_f32 v32, v32
v_exp_f32 v33, v33
v_exp_f32 v34, v34
v_exp_f32 v35, v35
v_exp_f32 v36, v36
v_exp_f32 v37, v37
v_exp_f32 v38, v38
v_exp_f32 v39, v39
v_pk_mul_f32 v[168:169], v[160:161], v[168:169]
v_pk_mul_f32 v[170:171], v[162:163], v[170:171]
v_pk_mul_f32 v[172:173], v[164:165], v[172:173]
v_pk_mul_f32 v[174:175], v[166:167], v[174:175]
v_pk_add_f32 v[32:33], v[32:33], 1.0 op_sel_hi:[1,0]
v_pk_add_f32 v[34:35], v[34:35], 1.0 op_sel_hi:[1,0]
v_pk_add_f32 v[36:37], v[36:37], 1.0 op_sel_hi:[1,0]
v_pk_add_f32 v[38:39], v[38:39], 1.0 op_sel_hi:[1,0]
v_rcp_f32 v32, v32
v_rcp_f32 v33, v33
v_rcp_f32 v34, v34
v_rcp_f32 v35, v35
v_rcp_f32 v36, v36
v_rcp_f32 v37, v37
v_rcp_f32 v38, v38
v_rcp_f32 v39, v39
s_nop 0
v_pk_mul_f32 v[32:33], v[32:33], v[168:169]
v_pk_mul_f32 v[34:35], v[34:35], v[170:171]
v_pk_mul_f32 v[36:37], v[36:37], v[172:173]
v_pk_mul_f32 v[38:39], v[38:39], v[174:175]
v_cvt_pk_bf16_f32 v40, v32, v33
v_cvt_pk_bf16_f32 v41, v34, v35
v_cvt_pk_bf16_f32 v42, v36, v37
v_cvt_pk_bf16_f32 v43, v38, v39
s_add_u32 s58, s57, 110592
buffer_store_dwordx4 v[40:43], v10, s[20:23], s58 offen sc1
v_pk_mul_f32 v[44:45], v[176:177], s[60:61]
v_pk_mul_f32 v[46:47], v[178:179], s[60:61]
v_pk_mul_f32 v[48:49], v[180:181], s[60:61]
v_pk_mul_f32 v[50:51], v[182:183], s[60:61]
v_exp_f32 v44, v44
v_exp_f32 v45, v45
v_exp_f32 v46, v46
v_exp_f32 v47, v47
v_exp_f32 v48, v48
v_exp_f32 v49, v49
v_exp_f32 v50, v50
v_exp_f32 v51, v51
v_pk_mul_f32 v[184:185], v[176:177], v[184:185]
v_pk_mul_f32 v[186:187], v[178:179], v[186:187]
v_pk_mul_f32 v[188:189], v[180:181], v[188:189]
v_pk_mul_f32 v[190:191], v[182:183], v[190:191]
v_pk_add_f32 v[44:45], v[44:45], 1.0 op_sel_hi:[1,0]
v_pk_add_f32 v[46:47], v[46:47], 1.0 op_sel_hi:[1,0]
v_pk_add_f32 v[48:49], v[48:49], 1.0 op_sel_hi:[1,0]
v_pk_add_f32 v[50:51], v[50:51], 1.0 op_sel_hi:[1,0]
v_rcp_f32 v44, v44
v_rcp_f32 v45, v45
v_rcp_f32 v46, v46
v_rcp_f32 v47, v47
v_rcp_f32 v48, v48
v_rcp_f32 v49, v49
v_rcp_f32 v50, v50
v_rcp_f32 v51, v51
s_nop 0
v_pk_mul_f32 v[44:45], v[44:45], v[184:185]
v_pk_mul_f32 v[46:47], v[46:47], v[186:187]
v_pk_mul_f32 v[48:49], v[48:49], v[188:189]
v_pk_mul_f32 v[50:51], v[50:51], v[190:191]
v_cvt_pk_bf16_f32 v52, v44, v45
v_cvt_pk_bf16_f32 v53, v46, v47
v_cvt_pk_bf16_f32 v54, v48, v49
v_cvt_pk_bf16_f32 v55, v50, v51
s_add_u32 s58, s57, 165888
buffer_store_dwordx4 v[52:55], v10, s[20:23], s58 offen sc1
v_pk_mul_f32 v[32:33], v[192:193], s[60:61]
v_pk_mul_f32 v[34:35], v[194:195], s[60:61]
v_pk_mul_f32 v[36:37], v[196:197], s[60:61]
v_pk_mul_f32 v[38:39], v[198:199], s[60:61]
v_exp_f32 v32, v32
v_exp_f32 v33, v33
v_exp_f32 v34, v34
v_exp_f32 v35, v35
v_exp_f32 v36, v36
v_exp_f32 v37, v37
v_exp_f32 v38, v38
v_exp_f32 v39, v39
v_pk_mul_f32 v[200:201], v[192:193], v[200:201]
v_pk_mul_f32 v[202:203], v[194:195], v[202:203]
v_pk_mul_f32 v[204:205], v[196:197], v[204:205]
v_pk_mul_f32 v[206:207], v[198:199], v[206:207]
v_pk_add_f32 v[32:33], v[32:33], 1.0 op_sel_hi:[1,0]
v_pk_add_f32 v[34:35], v[34:35], 1.0 op_sel_hi:[1,0]
v_pk_add_f32 v[36:37], v[36:37], 1.0 op_sel_hi:[1,0]
v_pk_add_f32 v[38:39], v[38:39], 1.0 op_sel_hi:[1,0]
v_rcp_f32 v32, v32
v_rcp_f32 v33, v33
v_rcp_f32 v34, v34
v_rcp_f32 v35, v35
v_rcp_f32 v36, v36
v_rcp_f32 v37, v37
v_rcp_f32 v38, v38
v_rcp_f32 v39, v39
s_nop 0
v_pk_mul_f32 v[32:33], v[32:33], v[200:201]
v_pk_mul_f32 v[34:35], v[34:35], v[202:203]
v_pk_mul_f32 v[36:37], v[36:37], v[204:205]
v_pk_mul_f32 v[38:39], v[38:39], v[206:207]
v_cvt_pk_bf16_f32 v40, v32, v33
v_cvt_pk_bf16_f32 v41, v34, v35
v_cvt_pk_bf16_f32 v42, v36, v37
v_cvt_pk_bf16_f32 v43, v38, v39
s_add_u32 s58, s57, 221184
buffer_store_dwordx4 v[40:43], v10, s[20:23], s58 offen sc1
v_pk_mul_f32 v[44:45], v[208:209], s[60:61]
v_pk_mul_f32 v[46:47], v[210:211], s[60:61]
v_pk_mul_f32 v[48:49], v[212:213], s[60:61]
v_pk_mul_f32 v[50:51], v[214:215], s[60:61]
v_exp_f32 v44, v44
v_exp_f32 v45, v45
v_exp_f32 v46, v46
v_exp_f32 v47, v47
v_exp_f32 v48, v48
v_exp_f32 v49, v49
v_exp_f32 v50, v50
v_exp_f32 v51, v51
v_pk_mul_f32 v[216:217], v[208:209], v[216:217]
v_pk_mul_f32 v[218:219], v[210:211], v[218:219]
v_pk_mul_f32 v[220:221], v[212:213], v[220:221]
v_pk_mul_f32 v[222:223], v[214:215], v[222:223]
v_pk_add_f32 v[44:45], v[44:45], 1.0 op_sel_hi:[1,0]
v_pk_add_f32 v[46:47], v[46:47], 1.0 op_sel_hi:[1,0]
v_pk_add_f32 v[48:49], v[48:49], 1.0 op_sel_hi:[1,0]
v_pk_add_f32 v[50:51], v[50:51], 1.0 op_sel_hi:[1,0]
v_rcp_f32 v44, v44
v_rcp_f32 v45, v45
v_rcp_f32 v46, v46
v_rcp_f32 v47, v47
v_rcp_f32 v48, v48
v_rcp_f32 v49, v49
v_rcp_f32 v50, v50
v_rcp_f32 v51, v51
s_nop 0
v_pk_mul_f32 v[44:45], v[44:45], v[216:217]
v_pk_mul_f32 v[46:47], v[46:47], v[218:219]
v_pk_mul_f32 v[48:49], v[48:49], v[220:221]
v_pk_mul_f32 v[50:51], v[50:51], v[222:223]
v_cvt_pk_bf16_f32 v52, v44, v45
v_cvt_pk_bf16_f32 v53, v46, v47
v_cvt_pk_bf16_f32 v54, v48, v49
v_cvt_pk_bf16_f32 v55, v50, v51
s_add_u32 s58, s57, 276480
buffer_store_dwordx4 v[52:55], v10, s[20:23], s58 offen sc1
v_pk_mul_f32 v[32:33], v[224:225], s[60:61]
v_pk_mul_f32 v[34:35], v[226:227], s[60:61]
v_pk_mul_f32 v[36:37], v[228:229], s[60:61]
v_pk_mul_f32 v[38:39], v[230:231], s[60:61]
v_exp_f32 v32, v32
v_exp_f32 v33, v33
v_exp_f32 v34, v34
v_exp_f32 v35, v35
v_exp_f32 v36, v36
v_exp_f32 v37, v37
v_exp_f32 v38, v38
v_exp_f32 v39, v39
v_pk_mul_f32 v[232:233], v[224:225], v[232:233]
v_pk_mul_f32 v[234:235], v[226:227], v[234:235]
v_pk_mul_f32 v[236:237], v[228:229], v[236:237]
v_pk_mul_f32 v[238:239], v[230:231], v[238:239]
v_pk_add_f32 v[32:33], v[32:33], 1.0 op_sel_hi:[1,0]
v_pk_add_f32 v[34:35], v[34:35], 1.0 op_sel_hi:[1,0]
v_pk_add_f32 v[36:37], v[36:37], 1.0 op_sel_hi:[1,0]
v_pk_add_f32 v[38:39], v[38:39], 1.0 op_sel_hi:[1,0]
v_rcp_f32 v32, v32
v_rcp_f32 v33, v33
v_rcp_f32 v34, v34
v_rcp_f32 v35, v35
v_rcp_f32 v36, v36
v_rcp_f32 v37, v37
v_rcp_f32 v38, v38
v_rcp_f32 v39, v39
s_nop 0
v_pk_mul_f32 v[32:33], v[32:33], v[232:233]
v_pk_mul_f32 v[34:35], v[34:35], v[234:235]
v_pk_mul_f32 v[36:37], v[36:37], v[236:237]
v_pk_mul_f32 v[38:39], v[38:39], v[238:239]
v_cvt_pk_bf16_f32 v40, v32, v33
v_cvt_pk_bf16_f32 v41, v34, v35
v_cvt_pk_bf16_f32 v42, v36, v37
v_cvt_pk_bf16_f32 v43, v38, v39
s_add_u32 s58, s57, 331776
buffer_store_dwordx4 v[40:43], v10, s[20:23], s58 offen sc1
v_pk_mul_f32 v[44:45], v[240:241], s[60:61]
v_pk_mul_f32 v[46:47], v[242:243], s[60:61]
v_pk_mul_f32 v[48:49], v[244:245], s[60:61]
v_pk_mul_f32 v[50:51], v[246:247], s[60:61]
v_exp_f32 v44, v44
v_exp_f32 v45, v45
v_exp_f32 v46, v46
v_exp_f32 v47, v47
v_exp_f32 v48, v48
v_exp_f32 v49, v49
v_exp_f32 v50, v50
v_exp_f32 v51, v51
v_pk_mul_f32 v[248:249], v[240:241], v[248:249]
v_pk_mul_f32 v[250:251], v[242:243], v[250:251]
v_pk_mul_f32 v[252:253], v[244:245], v[252:253]
v_pk_mul_f32 v[254:255], v[246:247], v[254:255]
v_pk_add_f32 v[44:45], v[44:45], 1.0 op_sel_hi:[1,0]
v_pk_add_f32 v[46:47], v[46:47], 1.0 op_sel_hi:[1,0]
v_pk_add_f32 v[48:49], v[48:49], 1.0 op_sel_hi:[1,0]
v_pk_add_f32 v[50:51], v[50:51], 1.0 op_sel_hi:[1,0]
v_rcp_f32 v44, v44
v_rcp_f32 v45, v45
v_rcp_f32 v46, v46
v_rcp_f32 v47, v47
v_rcp_f32 v48, v48
v_rcp_f32 v49, v49
v_rcp_f32 v50, v50
v_rcp_f32 v51, v51
s_nop 0
v_pk_mul_f32 v[44:45], v[44:45], v[248:249]
v_pk_mul_f32 v[46:47], v[46:47], v[250:251]
v_pk_mul_f32 v[48:49], v[48:49], v[252:253]
v_pk_mul_f32 v[50:51], v[50:51], v[254:255]
v_cvt_pk_bf16_f32 v52, v44, v45
v_cvt_pk_bf16_f32 v53, v46, v47
v_cvt_pk_bf16_f32 v54, v48, v49
v_cvt_pk_bf16_f32 v55, v50, v51
s_add_u32 s58, s57, 387072
buffer_store_dwordx4 v[52:55], v10, s[20:23], s58 offen sc1
s_waitcnt vmcnt(0)
v_mov_b32 v1, 1
v_mov_b32 v2, 163584
s_mov_b64 exec, 1
ds_add_rtn_u32 v3, v2, v1
s_waitcnt lgkmcnt(0)
v_readfirstlane_b32 s58, v3
s_mov_b64 exec, -1
s_cmp_lg_u32 s58, 3
s_cbranch_scc1 standalone__swiglu_ffn__prompt_kernel_nosig
s_lshl_b32 s58, s48, 7
s_lshl_b32 s59, s49, 2
s_add_u32 s58, s58, s59
s_add_u32 s58, s58, 12582912
v_lshlrev_b32 v2, 10, v0
v_add_u32 v2, s58, v2
s_mov_b32 exec_lo, -1
s_mov_b32 exec_hi, 0
global_store_dword v2, v1, s[44:45] sc1
s_mov_b64 exec, -1
standalone__swiglu_ffn__prompt_kernel_nosig:
s_barrier
v_lshrrev_b32 v12, 2, v0
v_mul_u32_u24 v12, 160, v12
v_and_b32 v13, 3, v0
v_lshlrev_b32 v13, 3, v13
v_add_u32 v12, v12, v13
v_add_u32 v13, 0x10000, v12
v_add_u32 v14, 0x20000, v12
v_mov_b32 v5, v10
v_add_u32 v6, 0x10000, v10
v_add_u32 v7, 0x20000, v10
s_lshl_b32 s57, s50, 2
s_lshl_b32 s58, s55, 1
s_add_u32 s57, s57, s58
s_mul_i32 s57, s57, 54
s_mul_i32 s58, s56, 27
s_add_u32 s57, s57, s58
s_lshl_b32 s57, s57, 10
v_add_u32 v11, 55296, v10
s_cmp_eq_u32 s56, 1
s_cbranch_scc1 standalone__swiglu_ffn__prompt_kernel_pre1n
ds_read_b64_tr_b16 v[56:57], v14 offset:17408
ds_read_b64_tr_b16 v[58:59], v14 offset:19968
ds_read_b64_tr_b16 v[60:61], v14 offset:17440
ds_read_b64_tr_b16 v[62:63], v14 offset:20000
ds_read_b64_tr_b16 v[64:65], v14 offset:17472
ds_read_b64_tr_b16 v[66:67], v14 offset:20032
ds_read_b64_tr_b16 v[68:69], v14 offset:17504
ds_read_b64_tr_b16 v[70:71], v14 offset:20064
ds_read_b64_tr_b16 v[72:73], v14 offset:17536
ds_read_b64_tr_b16 v[74:75], v14 offset:20096
ds_read_b64_tr_b16 v[76:77], v12 offset:35840
ds_read_b64_tr_b16 v[78:79], v12 offset:38400
ds_read_b64_tr_b16 v[80:81], v12 offset:35872
ds_read_b64_tr_b16 v[82:83], v12 offset:38432
ds_read_b64_tr_b16 v[84:85], v12 offset:35904
ds_read_b64_tr_b16 v[86:87], v12 offset:38464
ds_read_b64_tr_b16 v[88:89], v12 offset:35936
ds_read_b64_tr_b16 v[90:91], v12 offset:38496
ds_read_b64_tr_b16 v[92:93], v12 offset:35968
ds_read_b64_tr_b16 v[94:95], v12 offset:38528
ds_read_b64_tr_b16 v[96:97], v12 offset:46080
ds_read_b64_tr_b16 v[98:99], v12 offset:48640
ds_read_b64_tr_b16 v[100:101], v12 offset:46112
ds_read_b64_tr_b16 v[102:103], v12 offset:48672
ds_read_b64_tr_b16 v[104:105], v12 offset:46144
ds_read_b64_tr_b16 v[106:107], v12 offset:48704
ds_read_b64_tr_b16 v[108:109], v12 offset:46176
ds_read_b64_tr_b16 v[110:111], v12 offset:48736
ds_read_b64_tr_b16 v[112:113], v12 offset:46208
ds_read_b64_tr_b16 v[114:115], v12 offset:48768
ds_read_b64_tr_b16 v[116:117], v12 offset:56320
ds_read_b64_tr_b16 v[118:119], v12 offset:58880
ds_read_b64_tr_b16 v[120:121], v12 offset:56352
ds_read_b64_tr_b16 v[122:123], v12 offset:58912
ds_read_b64_tr_b16 v[124:125], v12 offset:56384
ds_read_b64_tr_b16 v[126:127], v12 offset:58944
ds_read_b64_tr_b16 v[128:129], v12 offset:56416
ds_read_b64_tr_b16 v[130:131], v12 offset:58976
ds_read_b64_tr_b16 v[132:133], v12 offset:56448
ds_read_b64_tr_b16 v[134:135], v12 offset:59008
s_branch standalone__swiglu_ffn__prompt_kernel_pre2n
standalone__swiglu_ffn__prompt_kernel_pre1n:
ds_read_b64_tr_b16 v[56:57], v14 offset:22528
ds_read_b64_tr_b16 v[58:59], v14 offset:25088
ds_read_b64_tr_b16 v[60:61], v14 offset:22560
ds_read_b64_tr_b16 v[62:63], v14 offset:25120
ds_read_b64_tr_b16 v[64:65], v14 offset:22592
ds_read_b64_tr_b16 v[66:67], v14 offset:25152
ds_read_b64_tr_b16 v[68:69], v14 offset:22624
ds_read_b64_tr_b16 v[70:71], v14 offset:25184
ds_read_b64_tr_b16 v[72:73], v14 offset:22656
ds_read_b64_tr_b16 v[74:75], v14 offset:25216
ds_read_b64_tr_b16 v[76:77], v12 offset:40960
ds_read_b64_tr_b16 v[78:79], v12 offset:43520
ds_read_b64_tr_b16 v[80:81], v12 offset:40992
ds_read_b64_tr_b16 v[82:83], v12 offset:43552
ds_read_b64_tr_b16 v[84:85], v12 offset:41024
ds_read_b64_tr_b16 v[86:87], v12 offset:43584
ds_read_b64_tr_b16 v[88:89], v12 offset:41056
ds_read_b64_tr_b16 v[90:91], v12 offset:43616
ds_read_b64_tr_b16 v[92:93], v12 offset:41088
ds_read_b64_tr_b16 v[94:95], v12 offset:43648
ds_read_b64_tr_b16 v[96:97], v12 offset:51200
ds_read_b64_tr_b16 v[98:99], v12 offset:53760
ds_read_b64_tr_b16 v[100:101], v12 offset:51232
ds_read_b64_tr_b16 v[102:103], v12 offset:53792
ds_read_b64_tr_b16 v[104:105], v12 offset:51264
ds_read_b64_tr_b16 v[106:107], v12 offset:53824
ds_read_b64_tr_b16 v[108:109], v12 offset:51296
ds_read_b64_tr_b16 v[110:111], v12 offset:53856
ds_read_b64_tr_b16 v[112:113], v12 offset:51328
ds_read_b64_tr_b16 v[114:115], v12 offset:53888
ds_read_b64_tr_b16 v[116:117], v13 offset:52224
ds_read_b64_tr_b16 v[118:119], v13 offset:54784
ds_read_b64_tr_b16 v[120:121], v13 offset:52256
ds_read_b64_tr_b16 v[122:123], v13 offset:54816
ds_read_b64_tr_b16 v[124:125], v13 offset:52288
ds_read_b64_tr_b16 v[126:127], v13 offset:54848
ds_read_b64_tr_b16 v[128:129], v13 offset:52320
ds_read_b64_tr_b16 v[130:131], v13 offset:54880
ds_read_b64_tr_b16 v[132:133], v13 offset:52352
ds_read_b64_tr_b16 v[134:135], v13 offset:54912
standalone__swiglu_ffn__prompt_kernel_pre2n:
s_waitcnt lgkmcnt(0)
v_mov_b32 v1, 163584
v_mov_b32 v2, 1
s_mov_b64 exec, 1
ds_add_u32 v1, v2 offset:16
s_mov_b64 exec, -1
standalone__swiglu_ffn__prompt_kernel_p2:
s_cmp_eq_u32 s56, 1
s_cbranch_scc1 standalone__swiglu_ffn__prompt_kernel_kh1
s_cmp_lg_u32 s3, 0
s_cbranch_scc1 standalone__swiglu_ffn__prompt_kernel_nopoll
s_mov_b32 s65, 400000
standalone__swiglu_ffn__prompt_kernel_h_poll:
global_load_dword v1, v16, s[62:63] sc1
s_waitcnt vmcnt(0)
v_cmp_eq_u32 vcc, 1, v1
s_nop 3
s_and_b32 s64, vcc_lo, 0x7ffffff
s_cmp_eq_u32 s64, 0x7ffffff
s_cbranch_scc1 standalone__swiglu_ffn__prompt_kernel_h_done
s_sub_u32 s65, s65, 1
s_cmp_lg_u32 s65, 0
s_cbranch_scc1 standalone__swiglu_ffn__prompt_kernel_h_poll
standalone__swiglu_ffn__prompt_kernel_h_done:
v_mov_b32 v1, 163584
v_mov_b32 v2, 1
ds_write_b32 v1, v2 offset:4
s_branch standalone__swiglu_ffn__prompt_kernel_go
standalone__swiglu_ffn__prompt_kernel_nopoll:
v_mov_b32 v1, 163584
s_mov_b32 s65, 400000
standalone__swiglu_ffn__prompt_kernel_gk0_poll:
ds_read_b32 v2, v1 offset:4
s_waitcnt lgkmcnt(0)
v_readfirstlane_b32 s64, v2
s_cmp_eq_u32 s64, 1
s_cbranch_scc1 standalone__swiglu_ffn__prompt_kernel_gk0_done
s_sub_u32 s65, s65, 1
s_cmp_lg_u32 s65, 0
s_cbranch_scc1 standalone__swiglu_ffn__prompt_kernel_gk0_poll
standalone__swiglu_ffn__prompt_kernel_gk0_done:
standalone__swiglu_ffn__prompt_kernel_go:
s_add_u32 s58, s57, 0
buffer_load_dwordx4 v[200:203], v10, s[20:23], s58 offen offset:0 sc1
buffer_load_dwordx4 v[204:207], v11, s[20:23], s58 offen offset:0 sc1
s_add_u32 s58, s57, 0
buffer_load_dwordx4 v[208:211], v10, s[20:23], s58 offen offset:1024 sc1
buffer_load_dwordx4 v[212:215], v11, s[20:23], s58 offen offset:1024 sc1
s_add_u32 s58, s57, 0
buffer_load_dwordx4 v[216:219], v10, s[20:23], s58 offen offset:2048 sc1
buffer_load_dwordx4 v[220:223], v11, s[20:23], s58 offen offset:2048 sc1
s_add_u32 s58, s57, 0
buffer_load_dwordx4 v[224:227], v10, s[20:23], s58 offen offset:3072 sc1
buffer_load_dwordx4 v[228:231], v11, s[20:23], s58 offen offset:3072 sc1
s_waitcnt vmcnt(6)
v_mfma_f32_16x16x32_bf16 v[16:19], v[56:59], v[200:203], 0
v_mfma_f32_16x16x32_bf16 v[36:39], v[56:59], v[204:207], 0
s_add_u32 s58, s57, 4096
buffer_load_dwordx4 v[232:235], v10, s[20:23], s58 offen offset:0 sc1
v_mfma_f32_16x16x32_bf16 v[20:23], v[60:63], v[200:203], 0
v_mfma_f32_16x16x32_bf16 v[40:43], v[60:63], v[204:207], 0
buffer_load_dwordx4 v[236:239], v11, s[20:23], s58 offen offset:0 sc1
v_mfma_f32_16x16x32_bf16 v[24:27], v[64:67], v[200:203], 0
v_mfma_f32_16x16x32_bf16 v[44:47], v[64:67], v[204:207], 0
s_add_u32 s58, s57, 4096
buffer_load_dwordx4 v[240:243], v10, s[20:23], s58 offen offset:1024 sc1
v_mfma_f32_16x16x32_bf16 v[28:31], v[68:71], v[200:203], 0
v_mfma_f32_16x16x32_bf16 v[48:51], v[68:71], v[204:207], 0
buffer_load_dwordx4 v[244:247], v11, s[20:23], s58 offen offset:1024 sc1
v_mfma_f32_16x16x32_bf16 v[32:35], v[72:75], v[200:203], 0
v_mfma_f32_16x16x32_bf16 v[52:55], v[72:75], v[204:207], 0
s_waitcnt vmcnt(8)
v_mfma_f32_16x16x32_bf16 v[16:19], v[76:79], v[208:211], v[16:19]
v_mfma_f32_16x16x32_bf16 v[36:39], v[76:79], v[212:215], v[36:39]
s_add_u32 s58, s57, 4096
buffer_load_dwordx4 v[248:251], v10, s[20:23], s58 offen offset:2048 sc1
v_mfma_f32_16x16x32_bf16 v[20:23], v[80:83], v[208:211], v[20:23]
v_mfma_f32_16x16x32_bf16 v[40:43], v[80:83], v[212:215], v[40:43]
buffer_load_dwordx4 v[252:255], v11, s[20:23], s58 offen offset:2048 sc1
v_mfma_f32_16x16x32_bf16 v[24:27], v[84:87], v[208:211], v[24:27]
v_mfma_f32_16x16x32_bf16 v[44:47], v[84:87], v[212:215], v[44:47]
s_add_u32 s58, s57, 4096
buffer_load_dwordx4 v[200:203], v10, s[20:23], s58 offen offset:3072 sc1
v_mfma_f32_16x16x32_bf16 v[28:31], v[88:91], v[208:211], v[28:31]
v_mfma_f32_16x16x32_bf16 v[48:51], v[88:91], v[212:215], v[48:51]
buffer_load_dwordx4 v[204:207], v11, s[20:23], s58 offen offset:3072 sc1
v_mfma_f32_16x16x32_bf16 v[32:35], v[92:95], v[208:211], v[32:35]
v_mfma_f32_16x16x32_bf16 v[52:55], v[92:95], v[212:215], v[52:55]
s_waitcnt vmcnt(10)
v_mfma_f32_16x16x32_bf16 v[16:19], v[96:99], v[216:219], v[16:19]
ds_read_b128 v[156:159], v6 offset:57344
v_mfma_f32_16x16x32_bf16 v[36:39], v[96:99], v[220:223], v[36:39]
v_mfma_f32_16x16x32_bf16 v[20:23], v[100:103], v[216:219], v[20:23]
ds_read_b128 v[160:163], v6 offset:58368
v_mfma_f32_16x16x32_bf16 v[40:43], v[100:103], v[220:223], v[40:43]
s_add_u32 s58, s57, 8192
buffer_load_dwordx4 v[208:211], v10, s[20:23], s58 offen offset:0 sc1
v_mfma_f32_16x16x32_bf16 v[24:27], v[104:107], v[216:219], v[24:27]
ds_read_b128 v[164:167], v6 offset:59392
v_mfma_f32_16x16x32_bf16 v[44:47], v[104:107], v[220:223], v[44:47]
v_mfma_f32_16x16x32_bf16 v[28:31], v[108:111], v[216:219], v[28:31]
ds_read_b128 v[168:171], v6 offset:60416
v_mfma_f32_16x16x32_bf16 v[48:51], v[108:111], v[220:223], v[48:51]
buffer_load_dwordx4 v[212:215], v11, s[20:23], s58 offen offset:0 sc1
v_mfma_f32_16x16x32_bf16 v[32:35], v[112:115], v[216:219], v[32:35]
ds_read_b128 v[172:175], v6 offset:61440
v_mfma_f32_16x16x32_bf16 v[52:55], v[112:115], v[220:223], v[52:55]
s_waitcnt vmcnt(10)
v_mfma_f32_16x16x32_bf16 v[16:19], v[116:119], v[224:227], v[16:19]
ds_read_b128 v[176:179], v6 offset:1024
v_mfma_f32_16x16x32_bf16 v[36:39], v[116:119], v[228:231], v[36:39]
v_mfma_f32_16x16x32_bf16 v[20:23], v[120:123], v[224:227], v[20:23]
ds_read_b128 v[180:183], v6 offset:2048
v_mfma_f32_16x16x32_bf16 v[40:43], v[120:123], v[228:231], v[40:43]
s_add_u32 s58, s57, 8192
buffer_load_dwordx4 v[216:219], v10, s[20:23], s58 offen offset:1024 sc1
v_mfma_f32_16x16x32_bf16 v[24:27], v[124:127], v[224:227], v[24:27]
ds_read_b128 v[184:187], v6 offset:3072
v_mfma_f32_16x16x32_bf16 v[44:47], v[124:127], v[228:231], v[44:47]
v_mfma_f32_16x16x32_bf16 v[28:31], v[128:131], v[224:227], v[28:31]
ds_read_b128 v[188:191], v6 offset:4096
v_mfma_f32_16x16x32_bf16 v[48:51], v[128:131], v[228:231], v[48:51]
buffer_load_dwordx4 v[220:223], v11, s[20:23], s58 offen offset:1024 sc1
v_mfma_f32_16x16x32_bf16 v[32:35], v[132:135], v[224:227], v[32:35]
ds_read_b128 v[192:195], v6 offset:5120
v_mfma_f32_16x16x32_bf16 v[52:55], v[132:135], v[228:231], v[52:55]
s_waitcnt vmcnt(10) lgkmcnt(5)
v_mfma_f32_16x16x32_bf16 v[16:19], v[156:159], v[232:235], v[16:19]
ds_read_b128 v[136:139], v6 offset:11264
v_mfma_f32_16x16x32_bf16 v[36:39], v[156:159], v[236:239], v[36:39]
v_mfma_f32_16x16x32_bf16 v[20:23], v[160:163], v[232:235], v[20:23]
ds_read_b128 v[140:143], v6 offset:12288
v_mfma_f32_16x16x32_bf16 v[40:43], v[160:163], v[236:239], v[40:43]
s_add_u32 s58, s57, 8192
buffer_load_dwordx4 v[224:227], v10, s[20:23], s58 offen offset:2048 sc1
v_mfma_f32_16x16x32_bf16 v[24:27], v[164:167], v[232:235], v[24:27]
ds_read_b128 v[144:147], v6 offset:13312
v_mfma_f32_16x16x32_bf16 v[44:47], v[164:167], v[236:239], v[44:47]
v_mfma_f32_16x16x32_bf16 v[28:31], v[168:171], v[232:235], v[28:31]
ds_read_b128 v[148:151], v6 offset:14336
v_mfma_f32_16x16x32_bf16 v[48:51], v[168:171], v[236:239], v[48:51]
buffer_load_dwordx4 v[228:231], v11, s[20:23], s58 offen offset:2048 sc1
v_mfma_f32_16x16x32_bf16 v[32:35], v[172:175], v[232:235], v[32:35]
ds_read_b128 v[152:155], v6 offset:15360
v_mfma_f32_16x16x32_bf16 v[52:55], v[172:175], v[236:239], v[52:55]
s_waitcnt vmcnt(10) lgkmcnt(5)
v_mfma_f32_16x16x32_bf16 v[16:19], v[176:179], v[240:243], v[16:19]
ds_read_b128 v[156:159], v6 offset:21504
v_mfma_f32_16x16x32_bf16 v[36:39], v[176:179], v[244:247], v[36:39]
v_mfma_f32_16x16x32_bf16 v[20:23], v[180:183], v[240:243], v[20:23]
ds_read_b128 v[160:163], v6 offset:22528
v_mfma_f32_16x16x32_bf16 v[40:43], v[180:183], v[244:247], v[40:43]
s_add_u32 s58, s57, 8192
buffer_load_dwordx4 v[232:235], v10, s[20:23], s58 offen offset:3072 sc1
v_mfma_f32_16x16x32_bf16 v[24:27], v[184:187], v[240:243], v[24:27]
ds_read_b128 v[164:167], v6 offset:23552
v_mfma_f32_16x16x32_bf16 v[44:47], v[184:187], v[244:247], v[44:47]
v_mfma_f32_16x16x32_bf16 v[28:31], v[188:191], v[240:243], v[28:31]
ds_read_b128 v[168:171], v6 offset:24576
v_mfma_f32_16x16x32_bf16 v[48:51], v[188:191], v[244:247], v[48:51]
buffer_load_dwordx4 v[236:239], v11, s[20:23], s58 offen offset:3072 sc1
v_mfma_f32_16x16x32_bf16 v[32:35], v[192:195], v[240:243], v[32:35]
ds_read_b128 v[172:175], v6 offset:25600
v_mfma_f32_16x16x32_bf16 v[52:55], v[192:195], v[244:247], v[52:55]
s_waitcnt vmcnt(10) lgkmcnt(5)
v_mfma_f32_16x16x32_bf16 v[16:19], v[136:139], v[248:251], v[16:19]
ds_read_b128 v[176:179], v6 offset:62464
v_mfma_f32_16x16x32_bf16 v[36:39], v[136:139], v[252:255], v[36:39]
v_mfma_f32_16x16x32_bf16 v[20:23], v[140:143], v[248:251], v[20:23]
ds_read_b128 v[180:183], v6 offset:63488
v_mfma_f32_16x16x32_bf16 v[40:43], v[140:143], v[252:255], v[40:43]
s_add_u32 s58, s57, 12288
buffer_load_dwordx4 v[240:243], v10, s[20:23], s58 offen offset:0 sc1
v_mfma_f32_16x16x32_bf16 v[24:27], v[144:147], v[248:251], v[24:27]
ds_read_b128 v[184:187], v6 offset:64512
v_mfma_f32_16x16x32_bf16 v[44:47], v[144:147], v[252:255], v[44:47]
v_mfma_f32_16x16x32_bf16 v[28:31], v[148:151], v[248:251], v[28:31]
ds_read_b128 v[188:191], v7 offset:0
v_mfma_f32_16x16x32_bf16 v[48:51], v[148:151], v[252:255], v[48:51]
buffer_load_dwordx4 v[244:247], v11, s[20:23], s58 offen offset:0 sc1
v_mfma_f32_16x16x32_bf16 v[32:35], v[152:155], v[248:251], v[32:35]
ds_read_b128 v[192:195], v7 offset:1024
v_mfma_f32_16x16x32_bf16 v[52:55], v[152:155], v[252:255], v[52:55]
s_waitcnt vmcnt(10) lgkmcnt(5)
s_barrier
v_mfma_f32_16x16x32_bf16 v[16:19], v[156:159], v[200:203], v[16:19]
ds_read_b128 v[136:139], v7 offset:7168
v_mfma_f32_16x16x32_bf16 v[36:39], v[156:159], v[204:207], v[36:39]
v_mfma_f32_16x16x32_bf16 v[20:23], v[160:163], v[200:203], v[20:23]
ds_read_b128 v[140:143], v7 offset:8192
v_mfma_f32_16x16x32_bf16 v[40:43], v[160:163], v[204:207], v[40:43]
s_add_u32 s58, s57, 12288
buffer_load_dwordx4 v[248:251], v10, s[20:23], s58 offen offset:1024 sc1
v_mfma_f32_16x16x32_bf16 v[24:27], v[164:167], v[200:203], v[24:27]
ds_read_b128 v[144:147], v7 offset:9216
v_mfma_f32_16x16x32_bf16 v[44:47], v[164:167], v[204:207], v[44:47]
v_mfma_f32_16x16x32_bf16 v[28:31], v[168:171], v[200:203], v[28:31]
ds_read_b128 v[148:151], v7 offset:10240
v_mfma_f32_16x16x32_bf16 v[48:51], v[168:171], v[204:207], v[48:51]
buffer_load_dwordx4 v[252:255], v11, s[20:23], s58 offen offset:1024 sc1
v_mfma_f32_16x16x32_bf16 v[32:35], v[172:175], v[200:203], v[32:35]
ds_read_b128 v[152:155], v7 offset:11264
v_mfma_f32_16x16x32_bf16 v[52:55], v[172:175], v[204:207], v[52:55]
s_waitcnt vmcnt(10) lgkmcnt(5)
v_mfma_f32_16x16x32_bf16 v[16:19], v[176:179], v[208:211], v[16:19]
ds_read_b128 v[156:159], v5 offset:0
v_mfma_f32_16x16x32_bf16 v[36:39], v[176:179], v[212:215], v[36:39]
v_mfma_f32_16x16x32_bf16 v[20:23], v[180:183], v[208:211], v[20:23]
ds_read_b128 v[160:163], v5 offset:1024
v_mfma_f32_16x16x32_bf16 v[40:43], v[180:183], v[212:215], v[40:43]
s_add_u32 s58, s57, 12288
buffer_load_dwordx4 v[200:203], v10, s[20:23], s58 offen offset:2048 sc1
v_mfma_f32_16x16x32_bf16 v[24:27], v[184:187], v[208:211], v[24:27]
ds_read_b128 v[164:167], v5 offset:2048
v_mfma_f32_16x16x32_bf16 v[44:47], v[184:187], v[212:215], v[44:47]
v_mfma_f32_16x16x32_bf16 v[28:31], v[188:191], v[208:211], v[28:31]
ds_read_b128 v[168:171], v5 offset:3072
v_mfma_f32_16x16x32_bf16 v[48:51], v[188:191], v[212:215], v[48:51]
buffer_load_dwordx4 v[204:207], v11, s[20:23], s58 offen offset:2048 sc1
v_mfma_f32_16x16x32_bf16 v[32:35], v[192:195], v[208:211], v[32:35]
ds_read_b128 v[172:175], v5 offset:4096
v_mfma_f32_16x16x32_bf16 v[52:55], v[192:195], v[212:215], v[52:55]
s_waitcnt vmcnt(10) lgkmcnt(5)
v_mfma_f32_16x16x32_bf16 v[16:19], v[136:139], v[216:219], v[16:19]
ds_read_b128 v[176:179], v5 offset:10240
v_mfma_f32_16x16x32_bf16 v[36:39], v[136:139], v[220:223], v[36:39]
v_mfma_f32_16x16x32_bf16 v[20:23], v[140:143], v[216:219], v[20:23]
ds_read_b128 v[180:183], v5 offset:11264
v_mfma_f32_16x16x32_bf16 v[40:43], v[140:143], v[220:223], v[40:43]
s_add_u32 s58, s57, 12288
buffer_load_dwordx4 v[208:211], v10, s[20:23], s58 offen offset:3072 sc1
v_mfma_f32_16x16x32_bf16 v[24:27], v[144:147], v[216:219], v[24:27]
ds_read_b128 v[184:187], v5 offset:12288
v_mfma_f32_16x16x32_bf16 v[44:47], v[144:147], v[220:223], v[44:47]
v_mfma_f32_16x16x32_bf16 v[28:31], v[148:151], v[216:219], v[28:31]
ds_read_b128 v[188:191], v5 offset:13312
v_mfma_f32_16x16x32_bf16 v[48:51], v[148:151], v[220:223], v[48:51]
buffer_load_dwordx4 v[212:215], v11, s[20:23], s58 offen offset:3072 sc1
v_mfma_f32_16x16x32_bf16 v[32:35], v[152:155], v[216:219], v[32:35]
ds_read_b128 v[192:195], v5 offset:14336
v_mfma_f32_16x16x32_bf16 v[52:55], v[152:155], v[220:223], v[52:55]
s_waitcnt vmcnt(10) lgkmcnt(5)
v_mfma_f32_16x16x32_bf16 v[16:19], v[156:159], v[224:227], v[16:19]
ds_read_b128 v[136:139], v5 offset:20480
v_mfma_f32_16x16x32_bf16 v[36:39], v[156:159], v[228:231], v[36:39]
v_mfma_f32_16x16x32_bf16 v[20:23], v[160:163], v[224:227], v[20:23]
ds_read_b128 v[140:143], v5 offset:21504
v_mfma_f32_16x16x32_bf16 v[40:43], v[160:163], v[228:231], v[40:43]
s_add_u32 s58, s57, 16384
buffer_load_dwordx4 v[216:219], v10, s[20:23], s58 offen offset:0 sc1
v_mfma_f32_16x16x32_bf16 v[24:27], v[164:167], v[224:227], v[24:27]
ds_read_b128 v[144:147], v5 offset:22528
v_mfma_f32_16x16x32_bf16 v[44:47], v[164:167], v[228:231], v[44:47]
v_mfma_f32_16x16x32_bf16 v[28:31], v[168:171], v[224:227], v[28:31]
ds_read_b128 v[148:151], v5 offset:23552
v_mfma_f32_16x16x32_bf16 v[48:51], v[168:171], v[228:231], v[48:51]
buffer_load_dwordx4 v[220:223], v11, s[20:23], s58 offen offset:0 sc1
v_mfma_f32_16x16x32_bf16 v[32:35], v[172:175], v[224:227], v[32:35]
ds_read_b128 v[152:155], v5 offset:24576
v_mfma_f32_16x16x32_bf16 v[52:55], v[172:175], v[228:231], v[52:55]
s_waitcnt vmcnt(10) lgkmcnt(5)
v_mfma_f32_16x16x32_bf16 v[16:19], v[176:179], v[232:235], v[16:19]
ds_read_b128 v[156:159], v5 offset:30720
v_mfma_f32_16x16x32_bf16 v[36:39], v[176:179], v[236:239], v[36:39]
v_mfma_f32_16x16x32_bf16 v[20:23], v[180:183], v[232:235], v[20:23]
ds_read_b128 v[160:163], v5 offset:31744
v_mfma_f32_16x16x32_bf16 v[40:43], v[180:183], v[236:239], v[40:43]
s_add_u32 s58, s57, 16384
buffer_load_dwordx4 v[224:227], v10, s[20:23], s58 offen offset:1024 sc1
v_mfma_f32_16x16x32_bf16 v[24:27], v[184:187], v[232:235], v[24:27]
ds_read_b128 v[164:167], v5 offset:32768
v_mfma_f32_16x16x32_bf16 v[44:47], v[184:187], v[236:239], v[44:47]
v_mfma_f32_16x16x32_bf16 v[28:31], v[188:191], v[232:235], v[28:31]
ds_read_b128 v[168:171], v5 offset:33792
v_mfma_f32_16x16x32_bf16 v[48:51], v[188:191], v[236:239], v[48:51]
buffer_load_dwordx4 v[228:231], v11, s[20:23], s58 offen offset:1024 sc1
v_mfma_f32_16x16x32_bf16 v[32:35], v[192:195], v[232:235], v[32:35]
ds_read_b128 v[172:175], v5 offset:34816
v_mfma_f32_16x16x32_bf16 v[52:55], v[192:195], v[236:239], v[52:55]
s_waitcnt vmcnt(10) lgkmcnt(5)
v_mfma_f32_16x16x32_bf16 v[16:19], v[136:139], v[240:243], v[16:19]
ds_read_b128 v[176:179], v7 offset:17408
v_mfma_f32_16x16x32_bf16 v[36:39], v[136:139], v[244:247], v[36:39]
v_mfma_f32_16x16x32_bf16 v[20:23], v[140:143], v[240:243], v[20:23]
ds_read_b128 v[180:183], v7 offset:18432
v_mfma_f32_16x16x32_bf16 v[40:43], v[140:143], v[244:247], v[40:43]
s_add_u32 s58, s57, 16384
buffer_load_dwordx4 v[232:235], v10, s[20:23], s58 offen offset:2048 sc1
v_mfma_f32_16x16x32_bf16 v[24:27], v[144:147], v[240:243], v[24:27]
ds_read_b128 v[184:187], v7 offset:19456
v_mfma_f32_16x16x32_bf16 v[44:47], v[144:147], v[244:247], v[44:47]
v_mfma_f32_16x16x32_bf16 v[28:31], v[148:151], v[240:243], v[28:31]
ds_read_b128 v[188:191], v7 offset:20480
v_mfma_f32_16x16x32_bf16 v[48:51], v[148:151], v[244:247], v[48:51]
buffer_load_dwordx4 v[236:239], v11, s[20:23], s58 offen offset:2048 sc1
v_mfma_f32_16x16x32_bf16 v[32:35], v[152:155], v[240:243], v[32:35]
ds_read_b128 v[192:195], v7 offset:21504
v_mfma_f32_16x16x32_bf16 v[52:55], v[152:155], v[244:247], v[52:55]
s_waitcnt vmcnt(10) lgkmcnt(5)
v_mfma_f32_16x16x32_bf16 v[16:19], v[156:159], v[248:251], v[16:19]
ds_read_b128 v[136:139], v5 offset:35840
v_mfma_f32_16x16x32_bf16 v[36:39], v[156:159], v[252:255], v[36:39]
v_mfma_f32_16x16x32_bf16 v[20:23], v[160:163], v[248:251], v[20:23]
ds_read_b128 v[140:143], v5 offset:36864
v_mfma_f32_16x16x32_bf16 v[40:43], v[160:163], v[252:255], v[40:43]
s_add_u32 s58, s57, 16384
buffer_load_dwordx4 v[240:243], v10, s[20:23], s58 offen offset:3072 sc1
v_mfma_f32_16x16x32_bf16 v[24:27], v[164:167], v[248:251], v[24:27]
ds_read_b128 v[144:147], v5 offset:37888
v_mfma_f32_16x16x32_bf16 v[44:47], v[164:167], v[252:255], v[44:47]
v_mfma_f32_16x16x32_bf16 v[28:31], v[168:171], v[248:251], v[28:31]
ds_read_b128 v[148:151], v5 offset:38912
v_mfma_f32_16x16x32_bf16 v[48:51], v[168:171], v[252:255], v[48:51]
buffer_load_dwordx4 v[244:247], v11, s[20:23], s58 offen offset:3072 sc1
v_mfma_f32_16x16x32_bf16 v[32:35], v[172:175], v[248:251], v[32:35]
ds_read_b128 v[152:155], v5 offset:39936
v_mfma_f32_16x16x32_bf16 v[52:55], v[172:175], v[252:255], v[52:55]
s_waitcnt vmcnt(10) lgkmcnt(5)
s_barrier
v_mfma_f32_16x16x32_bf16 v[16:19], v[176:179], v[200:203], v[16:19]
ds_read_b128 v[156:159], v5 offset:46080
v_mfma_f32_16x16x32_bf16 v[36:39], v[176:179], v[204:207], v[36:39]
v_mfma_f32_16x16x32_bf16 v[20:23], v[180:183], v[200:203], v[20:23]
ds_read_b128 v[160:163], v5 offset:47104
v_mfma_f32_16x16x32_bf16 v[40:43], v[180:183], v[204:207], v[40:43]
s_add_u32 s58, s57, 20480
buffer_load_dwordx4 v[248:251], v10, s[20:23], s58 offen offset:0 sc1
v_mfma_f32_16x16x32_bf16 v[24:27], v[184:187], v[200:203], v[24:27]
ds_read_b128 v[164:167], v5 offset:48128
v_mfma_f32_16x16x32_bf16 v[44:47], v[184:187], v[204:207], v[44:47]
v_mfma_f32_16x16x32_bf16 v[28:31], v[188:191], v[200:203], v[28:31]
ds_read_b128 v[168:171], v5 offset:49152
v_mfma_f32_16x16x32_bf16 v[48:51], v[188:191], v[204:207], v[48:51]
buffer_load_dwordx4 v[252:255], v11, s[20:23], s58 offen offset:0 sc1
v_mfma_f32_16x16x32_bf16 v[32:35], v[192:195], v[200:203], v[32:35]
ds_read_b128 v[172:175], v5 offset:50176
v_mfma_f32_16x16x32_bf16 v[52:55], v[192:195], v[204:207], v[52:55]
s_waitcnt vmcnt(10) lgkmcnt(5)
v_mfma_f32_16x16x32_bf16 v[16:19], v[136:139], v[208:211], v[16:19]
ds_read_b128 v[176:179], v5 offset:56320
v_mfma_f32_16x16x32_bf16 v[36:39], v[136:139], v[212:215], v[36:39]
v_mfma_f32_16x16x32_bf16 v[20:23], v[140:143], v[208:211], v[20:23]
ds_read_b128 v[180:183], v5 offset:57344
v_mfma_f32_16x16x32_bf16 v[40:43], v[140:143], v[212:215], v[40:43]
s_add_u32 s58, s57, 20480
buffer_load_dwordx4 v[200:203], v10, s[20:23], s58 offen offset:1024 sc1
v_mfma_f32_16x16x32_bf16 v[24:27], v[144:147], v[208:211], v[24:27]
ds_read_b128 v[184:187], v5 offset:58368
v_mfma_f32_16x16x32_bf16 v[44:47], v[144:147], v[212:215], v[44:47]
v_mfma_f32_16x16x32_bf16 v[28:31], v[148:151], v[208:211], v[28:31]
ds_read_b128 v[188:191], v5 offset:59392
v_mfma_f32_16x16x32_bf16 v[48:51], v[148:151], v[212:215], v[48:51]
buffer_load_dwordx4 v[204:207], v11, s[20:23], s58 offen offset:1024 sc1
v_mfma_f32_16x16x32_bf16 v[32:35], v[152:155], v[208:211], v[32:35]
ds_read_b128 v[192:195], v5 offset:60416
v_mfma_f32_16x16x32_bf16 v[52:55], v[152:155], v[212:215], v[52:55]
s_waitcnt vmcnt(10) lgkmcnt(5)
v_mfma_f32_16x16x32_bf16 v[16:19], v[156:159], v[216:219], v[16:19]
ds_read_b128 v[136:139], v6 offset:57344
v_mfma_f32_16x16x32_bf16 v[36:39], v[156:159], v[220:223], v[36:39]
v_mfma_f32_16x16x32_bf16 v[20:23], v[160:163], v[216:219], v[20:23]
ds_read_b128 v[140:143], v6 offset:58368
v_mfma_f32_16x16x32_bf16 v[40:43], v[160:163], v[220:223], v[40:43]
s_add_u32 s58, s57, 20480
buffer_load_dwordx4 v[208:211], v10, s[20:23], s58 offen offset:2048 sc1
v_mfma_f32_16x16x32_bf16 v[24:27], v[164:167], v[216:219], v[24:27]
ds_read_b128 v[144:147], v6 offset:59392
v_mfma_f32_16x16x32_bf16 v[44:47], v[164:167], v[220:223], v[44:47]
v_mfma_f32_16x16x32_bf16 v[28:31], v[168:171], v[216:219], v[28:31]
ds_read_b128 v[148:151], v6 offset:60416
v_mfma_f32_16x16x32_bf16 v[48:51], v[168:171], v[220:223], v[48:51]
buffer_load_dwordx4 v[212:215], v11, s[20:23], s58 offen offset:2048 sc1
v_mfma_f32_16x16x32_bf16 v[32:35], v[172:175], v[216:219], v[32:35]
ds_read_b128 v[152:155], v6 offset:61440
v_mfma_f32_16x16x32_bf16 v[52:55], v[172:175], v[220:223], v[52:55]
s_waitcnt vmcnt(10) lgkmcnt(5)
v_mfma_f32_16x16x32_bf16 v[16:19], v[176:179], v[224:227], v[16:19]
ds_read_b128 v[156:159], v6 offset:1024
v_mfma_f32_16x16x32_bf16 v[36:39], v[176:179], v[228:231], v[36:39]
v_mfma_f32_16x16x32_bf16 v[20:23], v[180:183], v[224:227], v[20:23]
ds_read_b128 v[160:163], v6 offset:2048
v_mfma_f32_16x16x32_bf16 v[40:43], v[180:183], v[228:231], v[40:43]
s_add_u32 s58, s57, 20480
buffer_load_dwordx4 v[216:219], v10, s[20:23], s58 offen offset:3072 sc1
v_mfma_f32_16x16x32_bf16 v[24:27], v[184:187], v[224:227], v[24:27]
ds_read_b128 v[164:167], v6 offset:3072
v_mfma_f32_16x16x32_bf16 v[44:47], v[184:187], v[228:231], v[44:47]
v_mfma_f32_16x16x32_bf16 v[28:31], v[188:191], v[224:227], v[28:31]
ds_read_b128 v[168:171], v6 offset:4096
v_mfma_f32_16x16x32_bf16 v[48:51], v[188:191], v[228:231], v[48:51]
buffer_load_dwordx4 v[220:223], v11, s[20:23], s58 offen offset:3072 sc1
v_mfma_f32_16x16x32_bf16 v[32:35], v[192:195], v[224:227], v[32:35]
ds_read_b128 v[172:175], v6 offset:5120
v_mfma_f32_16x16x32_bf16 v[52:55], v[192:195], v[228:231], v[52:55]
s_waitcnt vmcnt(10) lgkmcnt(5)
v_mfma_f32_16x16x32_bf16 v[16:19], v[136:139], v[232:235], v[16:19]
ds_read_b128 v[176:179], v6 offset:11264
v_mfma_f32_16x16x32_bf16 v[36:39], v[136:139], v[236:239], v[36:39]
v_mfma_f32_16x16x32_bf16 v[20:23], v[140:143], v[232:235], v[20:23]
ds_read_b128 v[180:183], v6 offset:12288
v_mfma_f32_16x16x32_bf16 v[40:43], v[140:143], v[236:239], v[40:43]
s_add_u32 s58, s57, 24576
buffer_load_dwordx4 v[224:227], v10, s[20:23], s58 offen offset:0 sc1
v_mfma_f32_16x16x32_bf16 v[24:27], v[144:147], v[232:235], v[24:27]
ds_read_b128 v[184:187], v6 offset:13312
v_mfma_f32_16x16x32_bf16 v[44:47], v[144:147], v[236:239], v[44:47]
v_mfma_f32_16x16x32_bf16 v[28:31], v[148:151], v[232:235], v[28:31]
ds_read_b128 v[188:191], v6 offset:14336
v_mfma_f32_16x16x32_bf16 v[48:51], v[148:151], v[236:239], v[48:51]
buffer_load_dwordx4 v[228:231], v11, s[20:23], s58 offen offset:0 sc1
v_mfma_f32_16x16x32_bf16 v[32:35], v[152:155], v[232:235], v[32:35]
ds_read_b128 v[192:195], v6 offset:15360
v_mfma_f32_16x16x32_bf16 v[52:55], v[152:155], v[236:239], v[52:55]
s_waitcnt vmcnt(10) lgkmcnt(5)
v_mfma_f32_16x16x32_bf16 v[16:19], v[156:159], v[240:243], v[16:19]
ds_read_b128 v[136:139], v6 offset:21504
v_mfma_f32_16x16x32_bf16 v[36:39], v[156:159], v[244:247], v[36:39]
v_mfma_f32_16x16x32_bf16 v[20:23], v[160:163], v[240:243], v[20:23]
ds_read_b128 v[140:143], v6 offset:22528
v_mfma_f32_16x16x32_bf16 v[40:43], v[160:163], v[244:247], v[40:43]
s_add_u32 s58, s57, 24576
buffer_load_dwordx4 v[232:235], v10, s[20:23], s58 offen offset:1024 sc1
v_mfma_f32_16x16x32_bf16 v[24:27], v[164:167], v[240:243], v[24:27]
ds_read_b128 v[144:147], v6 offset:23552
v_mfma_f32_16x16x32_bf16 v[44:47], v[164:167], v[244:247], v[44:47]
v_mfma_f32_16x16x32_bf16 v[28:31], v[168:171], v[240:243], v[28:31]
ds_read_b128 v[148:151], v6 offset:24576
v_mfma_f32_16x16x32_bf16 v[48:51], v[168:171], v[244:247], v[48:51]
buffer_load_dwordx4 v[236:239], v11, s[20:23], s58 offen offset:1024 sc1
v_mfma_f32_16x16x32_bf16 v[32:35], v[172:175], v[240:243], v[32:35]
ds_read_b128 v[152:155], v6 offset:25600
v_mfma_f32_16x16x32_bf16 v[52:55], v[172:175], v[244:247], v[52:55]
s_waitcnt vmcnt(10) lgkmcnt(5)
s_barrier
v_mfma_f32_16x16x32_bf16 v[16:19], v[176:179], v[248:251], v[16:19]
ds_read_b128 v[156:159], v6 offset:62464
v_mfma_f32_16x16x32_bf16 v[36:39], v[176:179], v[252:255], v[36:39]
v_mfma_f32_16x16x32_bf16 v[20:23], v[180:183], v[248:251], v[20:23]
ds_read_b128 v[160:163], v6 offset:63488
v_mfma_f32_16x16x32_bf16 v[40:43], v[180:183], v[252:255], v[40:43]
s_add_u32 s58, s57, 24576
buffer_load_dwordx4 v[240:243], v10, s[20:23], s58 offen offset:2048 sc1
v_mfma_f32_16x16x32_bf16 v[24:27], v[184:187], v[248:251], v[24:27]
ds_read_b128 v[164:167], v6 offset:64512
v_mfma_f32_16x16x32_bf16 v[44:47], v[184:187], v[252:255], v[44:47]
v_mfma_f32_16x16x32_bf16 v[28:31], v[188:191], v[248:251], v[28:31]
ds_read_b128 v[168:171], v7 offset:0
v_mfma_f32_16x16x32_bf16 v[48:51], v[188:191], v[252:255], v[48:51]
buffer_load_dwordx4 v[244:247], v11, s[20:23], s58 offen offset:2048 sc1
v_mfma_f32_16x16x32_bf16 v[32:35], v[192:195], v[248:251], v[32:35]
ds_read_b128 v[172:175], v7 offset:1024
v_mfma_f32_16x16x32_bf16 v[52:55], v[192:195], v[252:255], v[52:55]
s_waitcnt vmcnt(10) lgkmcnt(5)
v_mfma_f32_16x16x32_bf16 v[16:19], v[136:139], v[200:203], v[16:19]
ds_read_b128 v[176:179], v7 offset:7168
v_mfma_f32_16x16x32_bf16 v[36:39], v[136:139], v[204:207], v[36:39]
v_mfma_f32_16x16x32_bf16 v[20:23], v[140:143], v[200:203], v[20:23]
ds_read_b128 v[180:183], v7 offset:8192
v_mfma_f32_16x16x32_bf16 v[40:43], v[140:143], v[204:207], v[40:43]
v_mfma_f32_16x16x32_bf16 v[24:27], v[144:147], v[200:203], v[24:27]
ds_read_b128 v[184:187], v7 offset:9216
v_mfma_f32_16x16x32_bf16 v[44:47], v[144:147], v[204:207], v[44:47]
v_mfma_f32_16x16x32_bf16 v[28:31], v[148:151], v[200:203], v[28:31]
ds_read_b128 v[188:191], v7 offset:10240
v_mfma_f32_16x16x32_bf16 v[48:51], v[148:151], v[204:207], v[48:51]
v_mfma_f32_16x16x32_bf16 v[32:35], v[152:155], v[200:203], v[32:35]
ds_read_b128 v[192:195], v7 offset:11264
v_mfma_f32_16x16x32_bf16 v[52:55], v[152:155], v[204:207], v[52:55]
s_waitcnt vmcnt(8) lgkmcnt(5)
v_mfma_f32_16x16x32_bf16 v[16:19], v[156:159], v[208:211], v[16:19]
ds_read_b128 v[136:139], v5 offset:0
v_mfma_f32_16x16x32_bf16 v[36:39], v[156:159], v[212:215], v[36:39]
v_mfma_f32_16x16x32_bf16 v[20:23], v[160:163], v[208:211], v[20:23]
ds_read_b128 v[140:143], v5 offset:1024
v_mfma_f32_16x16x32_bf16 v[40:43], v[160:163], v[212:215], v[40:43]
v_mfma_f32_16x16x32_bf16 v[24:27], v[164:167], v[208:211], v[24:27]
ds_read_b128 v[144:147], v5 offset:2048
v_mfma_f32_16x16x32_bf16 v[44:47], v[164:167], v[212:215], v[44:47]
v_mfma_f32_16x16x32_bf16 v[28:31], v[168:171], v[208:211], v[28:31]
ds_read_b128 v[148:151], v5 offset:3072
v_mfma_f32_16x16x32_bf16 v[48:51], v[168:171], v[212:215], v[48:51]
v_mfma_f32_16x16x32_bf16 v[32:35], v[172:175], v[208:211], v[32:35]
ds_read_b128 v[152:155], v5 offset:4096
v_mfma_f32_16x16x32_bf16 v[52:55], v[172:175], v[212:215], v[52:55]
s_waitcnt vmcnt(6) lgkmcnt(5)
v_mfma_f32_16x16x32_bf16 v[16:19], v[176:179], v[216:219], v[16:19]
ds_read_b128 v[156:159], v5 offset:10240
v_mfma_f32_16x16x32_bf16 v[36:39], v[176:179], v[220:223], v[36:39]
v_mfma_f32_16x16x32_bf16 v[20:23], v[180:183], v[216:219], v[20:23]
ds_read_b128 v[160:163], v5 offset:11264
v_mfma_f32_16x16x32_bf16 v[40:43], v[180:183], v[220:223], v[40:43]
v_mfma_f32_16x16x32_bf16 v[24:27], v[184:187], v[216:219], v[24:27]
ds_read_b128 v[164:167], v5 offset:12288
v_mfma_f32_16x16x32_bf16 v[44:47], v[184:187], v[220:223], v[44:47]
v_mfma_f32_16x16x32_bf16 v[28:31], v[188:191], v[216:219], v[28:31]
ds_read_b128 v[168:171], v5 offset:13312
v_mfma_f32_16x16x32_bf16 v[48:51], v[188:191], v[220:223], v[48:51]
v_mfma_f32_16x16x32_bf16 v[32:35], v[192:195], v[216:219], v[32:35]
ds_read_b128 v[172:175], v5 offset:14336
v_mfma_f32_16x16x32_bf16 v[52:55], v[192:195], v[220:223], v[52:55]
s_waitcnt vmcnt(4) lgkmcnt(5)
v_mfma_f32_16x16x32_bf16 v[16:19], v[136:139], v[224:227], v[16:19]
ds_read_b128 v[176:179], v6 offset:36864
v_mfma_f32_16x16x32_bf16 v[36:39], v[136:139], v[228:231], v[36:39]
v_mfma_f32_16x16x32_bf16 v[20:23], v[140:143], v[224:227], v[20:23]
ds_read_b128 v[180:183], v6 offset:37888
v_mfma_f32_16x16x32_bf16 v[40:43], v[140:143], v[228:231], v[40:43]
v_mfma_f32_16x16x32_bf16 v[24:27], v[144:147], v[224:227], v[24:27]
ds_read_b128 v[184:187], v6 offset:38912
v_mfma_f32_16x16x32_bf16 v[44:47], v[144:147], v[228:231], v[44:47]
v_mfma_f32_16x16x32_bf16 v[28:31], v[148:151], v[224:227], v[28:31]
ds_read_b128 v[188:191], v6 offset:39936
v_mfma_f32_16x16x32_bf16 v[48:51], v[148:151], v[228:231], v[48:51]
v_mfma_f32_16x16x32_bf16 v[32:35], v[152:155], v[224:227], v[32:35]
ds_read_b128 v[192:195], v6 offset:40960
v_mfma_f32_16x16x32_bf16 v[52:55], v[152:155], v[228:231], v[52:55]
s_waitcnt vmcnt(2) lgkmcnt(5)
v_mfma_f32_16x16x32_bf16 v[16:19], v[156:159], v[232:235], v[16:19]
v_mfma_f32_16x16x32_bf16 v[36:39], v[156:159], v[236:239], v[36:39]
v_mfma_f32_16x16x32_bf16 v[20:23], v[160:163], v[232:235], v[20:23]
v_mfma_f32_16x16x32_bf16 v[40:43], v[160:163], v[236:239], v[40:43]
v_mfma_f32_16x16x32_bf16 v[24:27], v[164:167], v[232:235], v[24:27]
v_mfma_f32_16x16x32_bf16 v[44:47], v[164:167], v[236:239], v[44:47]
v_mfma_f32_16x16x32_bf16 v[28:31], v[168:171], v[232:235], v[28:31]
v_mfma_f32_16x16x32_bf16 v[48:51], v[168:171], v[236:239], v[48:51]
v_mfma_f32_16x16x32_bf16 v[32:35], v[172:175], v[232:235], v[32:35]
v_mfma_f32_16x16x32_bf16 v[52:55], v[172:175], v[236:239], v[52:55]
s_waitcnt vmcnt(0) lgkmcnt(0)
v_mfma_f32_16x16x32_bf16 v[16:19], v[176:179], v[240:243], v[16:19]
v_mfma_f32_16x16x32_bf16 v[36:39], v[176:179], v[244:247], v[36:39]
v_mfma_f32_16x16x32_bf16 v[20:23], v[180:183], v[240:243], v[20:23]
v_mfma_f32_16x16x32_bf16 v[40:43], v[180:183], v[244:247], v[40:43]
v_mfma_f32_16x16x32_bf16 v[24:27], v[184:187], v[240:243], v[24:27]
v_mfma_f32_16x16x32_bf16 v[44:47], v[184:187], v[244:247], v[44:47]
v_mfma_f32_16x16x32_bf16 v[28:31], v[188:191], v[240:243], v[28:31]
v_mfma_f32_16x16x32_bf16 v[48:51], v[188:191], v[244:247], v[48:51]
v_mfma_f32_16x16x32_bf16 v[32:35], v[192:195], v[240:243], v[32:35]
v_mfma_f32_16x16x32_bf16 v[52:55], v[192:195], v[244:247], v[52:55]
s_mov_b32 s59, 25600
s_cmp_eq_u32 s55, 1
s_cselect_b32 s59, 97280, s59
v_add_u32 v4, s59, v10
s_mov_b32 s59, 20480
s_cmp_eq_u32 s55, 1
s_cselect_b32 s59, 30720, s59
v_add_u32 v15, s59, v10
s_nop 1
ds_write_b128 v4, v[36:39] offset:0
ds_write_b128 v4, v[40:43] offset:1024
ds_write_b128 v4, v[44:47] offset:2048
ds_write_b128 v4, v[48:51] offset:3072
ds_write_b128 v4, v[52:55] offset:4096
v_and_b32 v4, 15, v0
v_mul_u32_u24 v4, 1280, v4
v_lshrrev_b32 v6, 4, v0
v_lshrrev_b32 v7, 1, v6
v_lshlrev_b32 v7, 4, v7
v_and_b32 v5, 1, v6
v_lshlrev_b32 v5, 5, v5
v_add_u32 v7, v7, v5
v_add_u32 v7, v4, v7
v_lshlrev_b32 v6, 3, v6
v_add_u32 v4, v4, v6
s_lshl_b32 s57, s50, 6
s_lshl_b32 s58, s55, 5
s_add_u32 s57, s57, s58
s_add_u32 s57, s57, 0
s_mul_i32 s57, s57, 1280
s_mul_i32 s58, s51, 160
s_add_u32 s57, s57, s58
s_waitcnt lgkmcnt(0)
s_barrier
ds_read_b128 v[64:67], v15 offset:0
ds_read_b128 v[68:71], v15 offset:1024
ds_read_b128 v[72:75], v15 offset:2048
ds_read_b128 v[76:79], v15 offset:3072
ds_read_b128 v[80:83], v15 offset:4096
s_waitcnt lgkmcnt(4)
v_pk_add_f32 v[16:17], v[16:17], v[64:65]
v_pk_add_f32 v[18:19], v[18:19], v[66:67]
v_cvt_pk_bf16_f32 v96, v16, v17
v_cvt_pk_bf16_f32 v97, v18, v19
s_waitcnt lgkmcnt(3)
v_pk_add_f32 v[20:21], v[20:21], v[68:69]
v_pk_add_f32 v[22:23], v[22:23], v[70:71]
v_cvt_pk_bf16_f32 v98, v20, v21
v_cvt_pk_bf16_f32 v99, v22, v23
s_nop 1
v_permlane16_swap_b32 v96, v98
v_permlane16_swap_b32 v97, v99
buffer_store_dwordx4 v[96:99], v7, s[28:31], s57 offen offset:0
s_waitcnt lgkmcnt(2)
v_pk_add_f32 v[24:25], v[24:25], v[72:73]
v_pk_add_f32 v[26:27], v[26:27], v[74:75]
v_cvt_pk_bf16_f32 v100, v24, v25
v_cvt_pk_bf16_f32 v101, v26, v27
s_waitcnt lgkmcnt(1)
v_pk_add_f32 v[28:29], v[28:29], v[76:77]
v_pk_add_f32 v[30:31], v[30:31], v[78:79]
v_cvt_pk_bf16_f32 v102, v28, v29
v_cvt_pk_bf16_f32 v103, v30, v31
s_nop 1
v_permlane16_swap_b32 v100, v102
v_permlane16_swap_b32 v101, v103
buffer_store_dwordx4 v[100:103], v7, s[28:31], s57 offen offset:64
s_waitcnt lgkmcnt(0)
v_pk_add_f32 v[32:33], v[32:33], v[80:81]
v_pk_add_f32 v[34:35], v[34:35], v[82:83]
v_cvt_pk_bf16_f32 v104, v32, v33
v_cvt_pk_bf16_f32 v105, v34, v35
buffer_store_dwordx2 v[104:105], v4, s[28:31], s57 offen offset:128
s_endpgm
standalone__swiglu_ffn__prompt_kernel_kh1:
v_mov_b32 v1, 163584
s_mov_b32 s65, 400000
standalone__swiglu_ffn__prompt_kernel_gk1_poll:
ds_read_b32 v2, v1 offset:4
s_waitcnt lgkmcnt(0)
v_readfirstlane_b32 s64, v2
s_cmp_eq_u32 s64, 1
s_cbranch_scc1 standalone__swiglu_ffn__prompt_kernel_gk1_done
s_sub_u32 s65, s65, 1
s_cmp_lg_u32 s65, 0
s_cbranch_scc1 standalone__swiglu_ffn__prompt_kernel_gk1_poll
standalone__swiglu_ffn__prompt_kernel_gk1_done:
s_add_u32 s58, s57, 0
buffer_load_dwordx4 v[200:203], v10, s[20:23], s58 offen offset:0 sc1
buffer_load_dwordx4 v[204:207], v11, s[20:23], s58 offen offset:0 sc1
s_add_u32 s58, s57, 0
buffer_load_dwordx4 v[208:211], v10, s[20:23], s58 offen offset:1024 sc1
buffer_load_dwordx4 v[212:215], v11, s[20:23], s58 offen offset:1024 sc1
s_add_u32 s58, s57, 0
buffer_load_dwordx4 v[216:219], v10, s[20:23], s58 offen offset:2048 sc1
buffer_load_dwordx4 v[220:223], v11, s[20:23], s58 offen offset:2048 sc1
s_add_u32 s58, s57, 0
buffer_load_dwordx4 v[224:227], v10, s[20:23], s58 offen offset:3072 sc1
buffer_load_dwordx4 v[228:231], v11, s[20:23], s58 offen offset:3072 sc1
s_waitcnt vmcnt(6)
v_mfma_f32_16x16x32_bf16 v[16:19], v[56:59], v[200:203], 0
v_mfma_f32_16x16x32_bf16 v[36:39], v[56:59], v[204:207], 0
s_add_u32 s58, s57, 4096
buffer_load_dwordx4 v[232:235], v10, s[20:23], s58 offen offset:0 sc1
v_mfma_f32_16x16x32_bf16 v[20:23], v[60:63], v[200:203], 0
v_mfma_f32_16x16x32_bf16 v[40:43], v[60:63], v[204:207], 0
buffer_load_dwordx4 v[236:239], v11, s[20:23], s58 offen offset:0 sc1
v_mfma_f32_16x16x32_bf16 v[24:27], v[64:67], v[200:203], 0
v_mfma_f32_16x16x32_bf16 v[44:47], v[64:67], v[204:207], 0
s_add_u32 s58, s57, 4096
buffer_load_dwordx4 v[240:243], v10, s[20:23], s58 offen offset:1024 sc1
v_mfma_f32_16x16x32_bf16 v[28:31], v[68:71], v[200:203], 0
v_mfma_f32_16x16x32_bf16 v[48:51], v[68:71], v[204:207], 0
buffer_load_dwordx4 v[244:247], v11, s[20:23], s58 offen offset:1024 sc1
v_mfma_f32_16x16x32_bf16 v[32:35], v[72:75], v[200:203], 0
v_mfma_f32_16x16x32_bf16 v[52:55], v[72:75], v[204:207], 0
s_waitcnt vmcnt(8)
v_mfma_f32_16x16x32_bf16 v[16:19], v[76:79], v[208:211], v[16:19]
v_mfma_f32_16x16x32_bf16 v[36:39], v[76:79], v[212:215], v[36:39]
s_add_u32 s58, s57, 4096
buffer_load_dwordx4 v[248:251], v10, s[20:23], s58 offen offset:2048 sc1
v_mfma_f32_16x16x32_bf16 v[20:23], v[80:83], v[208:211], v[20:23]
v_mfma_f32_16x16x32_bf16 v[40:43], v[80:83], v[212:215], v[40:43]
buffer_load_dwordx4 v[252:255], v11, s[20:23], s58 offen offset:2048 sc1
v_mfma_f32_16x16x32_bf16 v[24:27], v[84:87], v[208:211], v[24:27]
v_mfma_f32_16x16x32_bf16 v[44:47], v[84:87], v[212:215], v[44:47]
s_add_u32 s58, s57, 4096
buffer_load_dwordx4 v[200:203], v10, s[20:23], s58 offen offset:3072 sc1
v_mfma_f32_16x16x32_bf16 v[28:31], v[88:91], v[208:211], v[28:31]
v_mfma_f32_16x16x32_bf16 v[48:51], v[88:91], v[212:215], v[48:51]
buffer_load_dwordx4 v[204:207], v11, s[20:23], s58 offen offset:3072 sc1
v_mfma_f32_16x16x32_bf16 v[32:35], v[92:95], v[208:211], v[32:35]
v_mfma_f32_16x16x32_bf16 v[52:55], v[92:95], v[212:215], v[52:55]
s_waitcnt vmcnt(10)
v_mfma_f32_16x16x32_bf16 v[16:19], v[96:99], v[216:219], v[16:19]
ds_read_b128 v[156:159], v5 offset:61440
v_mfma_f32_16x16x32_bf16 v[36:39], v[96:99], v[220:223], v[36:39]
v_mfma_f32_16x16x32_bf16 v[20:23], v[100:103], v[216:219], v[20:23]
ds_read_b128 v[160:163], v5 offset:62464
v_mfma_f32_16x16x32_bf16 v[40:43], v[100:103], v[220:223], v[40:43]
s_add_u32 s58, s57, 8192
buffer_load_dwordx4 v[208:211], v10, s[20:23], s58 offen offset:0 sc1
v_mfma_f32_16x16x32_bf16 v[24:27], v[104:107], v[216:219], v[24:27]
ds_read_b128 v[164:167], v5 offset:63488
v_mfma_f32_16x16x32_bf16 v[44:47], v[104:107], v[220:223], v[44:47]
v_mfma_f32_16x16x32_bf16 v[28:31], v[108:111], v[216:219], v[28:31]
ds_read_b128 v[168:171], v5 offset:64512
v_mfma_f32_16x16x32_bf16 v[48:51], v[108:111], v[220:223], v[48:51]
buffer_load_dwordx4 v[212:215], v11, s[20:23], s58 offen offset:0 sc1
v_mfma_f32_16x16x32_bf16 v[32:35], v[112:115], v[216:219], v[32:35]
ds_read_b128 v[172:175], v6 offset:0
v_mfma_f32_16x16x32_bf16 v[52:55], v[112:115], v[220:223], v[52:55]
s_waitcnt vmcnt(10)
v_mfma_f32_16x16x32_bf16 v[16:19], v[116:119], v[224:227], v[16:19]
ds_read_b128 v[176:179], v6 offset:6144
v_mfma_f32_16x16x32_bf16 v[36:39], v[116:119], v[228:231], v[36:39]
v_mfma_f32_16x16x32_bf16 v[20:23], v[120:123], v[224:227], v[20:23]
ds_read_b128 v[180:183], v6 offset:7168
v_mfma_f32_16x16x32_bf16 v[40:43], v[120:123], v[228:231], v[40:43]
s_add_u32 s58, s57, 8192
buffer_load_dwordx4 v[216:219], v10, s[20:23], s58 offen offset:1024 sc1
v_mfma_f32_16x16x32_bf16 v[24:27], v[124:127], v[224:227], v[24:27]
ds_read_b128 v[184:187], v6 offset:8192
v_mfma_f32_16x16x32_bf16 v[44:47], v[124:127], v[228:231], v[44:47]
v_mfma_f32_16x16x32_bf16 v[28:31], v[128:131], v[224:227], v[28:31]
ds_read_b128 v[188:191], v6 offset:9216
v_mfma_f32_16x16x32_bf16 v[48:51], v[128:131], v[228:231], v[48:51]
buffer_load_dwordx4 v[220:223], v11, s[20:23], s58 offen offset:1024 sc1
v_mfma_f32_16x16x32_bf16 v[32:35], v[132:135], v[224:227], v[32:35]
ds_read_b128 v[192:195], v6 offset:10240
v_mfma_f32_16x16x32_bf16 v[52:55], v[132:135], v[228:231], v[52:55]
s_waitcnt vmcnt(10) lgkmcnt(5)
v_mfma_f32_16x16x32_bf16 v[16:19], v[156:159], v[232:235], v[16:19]
ds_read_b128 v[136:139], v6 offset:16384
v_mfma_f32_16x16x32_bf16 v[36:39], v[156:159], v[236:239], v[36:39]
v_mfma_f32_16x16x32_bf16 v[20:23], v[160:163], v[232:235], v[20:23]
ds_read_b128 v[140:143], v6 offset:17408
v_mfma_f32_16x16x32_bf16 v[40:43], v[160:163], v[236:239], v[40:43]
s_add_u32 s58, s57, 8192
buffer_load_dwordx4 v[224:227], v10, s[20:23], s58 offen offset:2048 sc1
v_mfma_f32_16x16x32_bf16 v[24:27], v[164:167], v[232:235], v[24:27]
ds_read_b128 v[144:147], v6 offset:18432
v_mfma_f32_16x16x32_bf16 v[44:47], v[164:167], v[236:239], v[44:47]
v_mfma_f32_16x16x32_bf16 v[28:31], v[168:171], v[232:235], v[28:31]
ds_read_b128 v[148:151], v6 offset:19456
v_mfma_f32_16x16x32_bf16 v[48:51], v[168:171], v[236:239], v[48:51]
buffer_load_dwordx4 v[228:231], v11, s[20:23], s58 offen offset:2048 sc1
v_mfma_f32_16x16x32_bf16 v[32:35], v[172:175], v[232:235], v[32:35]
ds_read_b128 v[152:155], v6 offset:20480
v_mfma_f32_16x16x32_bf16 v[52:55], v[172:175], v[236:239], v[52:55]
s_waitcnt vmcnt(10) lgkmcnt(5)
v_mfma_f32_16x16x32_bf16 v[16:19], v[176:179], v[240:243], v[16:19]
ds_read_b128 v[156:159], v6 offset:26624
v_mfma_f32_16x16x32_bf16 v[36:39], v[176:179], v[244:247], v[36:39]
v_mfma_f32_16x16x32_bf16 v[20:23], v[180:183], v[240:243], v[20:23]
ds_read_b128 v[160:163], v6 offset:27648
v_mfma_f32_16x16x32_bf16 v[40:43], v[180:183], v[244:247], v[40:43]
s_add_u32 s58, s57, 8192
buffer_load_dwordx4 v[232:235], v10, s[20:23], s58 offen offset:3072 sc1
v_mfma_f32_16x16x32_bf16 v[24:27], v[184:187], v[240:243], v[24:27]
ds_read_b128 v[164:167], v6 offset:28672
v_mfma_f32_16x16x32_bf16 v[44:47], v[184:187], v[244:247], v[44:47]
v_mfma_f32_16x16x32_bf16 v[28:31], v[188:191], v[240:243], v[28:31]
ds_read_b128 v[168:171], v6 offset:29696
v_mfma_f32_16x16x32_bf16 v[48:51], v[188:191], v[244:247], v[48:51]
buffer_load_dwordx4 v[236:239], v11, s[20:23], s58 offen offset:3072 sc1
v_mfma_f32_16x16x32_bf16 v[32:35], v[192:195], v[240:243], v[32:35]
ds_read_b128 v[172:175], v6 offset:30720
v_mfma_f32_16x16x32_bf16 v[52:55], v[192:195], v[244:247], v[52:55]
s_waitcnt vmcnt(10) lgkmcnt(5)
v_mfma_f32_16x16x32_bf16 v[16:19], v[136:139], v[248:251], v[16:19]
ds_read_b128 v[176:179], v7 offset:2048
v_mfma_f32_16x16x32_bf16 v[36:39], v[136:139], v[252:255], v[36:39]
v_mfma_f32_16x16x32_bf16 v[20:23], v[140:143], v[248:251], v[20:23]
ds_read_b128 v[180:183], v7 offset:3072
v_mfma_f32_16x16x32_bf16 v[40:43], v[140:143], v[252:255], v[40:43]
s_add_u32 s58, s57, 12288
buffer_load_dwordx4 v[240:243], v10, s[20:23], s58 offen offset:0 sc1
v_mfma_f32_16x16x32_bf16 v[24:27], v[144:147], v[248:251], v[24:27]
ds_read_b128 v[184:187], v7 offset:4096
v_mfma_f32_16x16x32_bf16 v[44:47], v[144:147], v[252:255], v[44:47]
v_mfma_f32_16x16x32_bf16 v[28:31], v[148:151], v[248:251], v[28:31]
ds_read_b128 v[188:191], v7 offset:5120
v_mfma_f32_16x16x32_bf16 v[48:51], v[148:151], v[252:255], v[48:51]
buffer_load_dwordx4 v[244:247], v11, s[20:23], s58 offen offset:0 sc1
v_mfma_f32_16x16x32_bf16 v[32:35], v[152:155], v[248:251], v[32:35]
ds_read_b128 v[192:195], v7 offset:6144
v_mfma_f32_16x16x32_bf16 v[52:55], v[152:155], v[252:255], v[52:55]
s_waitcnt vmcnt(10) lgkmcnt(5)
s_barrier
v_mfma_f32_16x16x32_bf16 v[16:19], v[156:159], v[200:203], v[16:19]
ds_read_b128 v[136:139], v7 offset:12288
v_mfma_f32_16x16x32_bf16 v[36:39], v[156:159], v[204:207], v[36:39]
v_mfma_f32_16x16x32_bf16 v[20:23], v[160:163], v[200:203], v[20:23]
ds_read_b128 v[140:143], v7 offset:13312
v_mfma_f32_16x16x32_bf16 v[40:43], v[160:163], v[204:207], v[40:43]
s_add_u32 s58, s57, 12288
buffer_load_dwordx4 v[248:251], v10, s[20:23], s58 offen offset:1024 sc1
v_mfma_f32_16x16x32_bf16 v[24:27], v[164:167], v[200:203], v[24:27]
ds_read_b128 v[144:147], v7 offset:14336
v_mfma_f32_16x16x32_bf16 v[44:47], v[164:167], v[204:207], v[44:47]
v_mfma_f32_16x16x32_bf16 v[28:31], v[168:171], v[200:203], v[28:31]
ds_read_b128 v[148:151], v7 offset:15360
v_mfma_f32_16x16x32_bf16 v[48:51], v[168:171], v[204:207], v[48:51]
buffer_load_dwordx4 v[252:255], v11, s[20:23], s58 offen offset:1024 sc1
v_mfma_f32_16x16x32_bf16 v[32:35], v[172:175], v[200:203], v[32:35]
ds_read_b128 v[152:155], v7 offset:16384
v_mfma_f32_16x16x32_bf16 v[52:55], v[172:175], v[204:207], v[52:55]
s_waitcnt vmcnt(10) lgkmcnt(5)
v_mfma_f32_16x16x32_bf16 v[16:19], v[176:179], v[208:211], v[16:19]
ds_read_b128 v[156:159], v5 offset:5120
v_mfma_f32_16x16x32_bf16 v[36:39], v[176:179], v[212:215], v[36:39]
v_mfma_f32_16x16x32_bf16 v[20:23], v[180:183], v[208:211], v[20:23]
ds_read_b128 v[160:163], v5 offset:6144
v_mfma_f32_16x16x32_bf16 v[40:43], v[180:183], v[212:215], v[40:43]
s_add_u32 s58, s57, 12288
buffer_load_dwordx4 v[200:203], v10, s[20:23], s58 offen offset:2048 sc1
v_mfma_f32_16x16x32_bf16 v[24:27], v[184:187], v[208:211], v[24:27]
ds_read_b128 v[164:167], v5 offset:7168
v_mfma_f32_16x16x32_bf16 v[44:47], v[184:187], v[212:215], v[44:47]
v_mfma_f32_16x16x32_bf16 v[28:31], v[188:191], v[208:211], v[28:31]
ds_read_b128 v[168:171], v5 offset:8192
v_mfma_f32_16x16x32_bf16 v[48:51], v[188:191], v[212:215], v[48:51]
buffer_load_dwordx4 v[204:207], v11, s[20:23], s58 offen offset:2048 sc1
v_mfma_f32_16x16x32_bf16 v[32:35], v[192:195], v[208:211], v[32:35]
ds_read_b128 v[172:175], v5 offset:9216
v_mfma_f32_16x16x32_bf16 v[52:55], v[192:195], v[212:215], v[52:55]
s_waitcnt vmcnt(10) lgkmcnt(5)
v_mfma_f32_16x16x32_bf16 v[16:19], v[136:139], v[216:219], v[16:19]
ds_read_b128 v[176:179], v5 offset:15360
v_mfma_f32_16x16x32_bf16 v[36:39], v[136:139], v[220:223], v[36:39]
v_mfma_f32_16x16x32_bf16 v[20:23], v[140:143], v[216:219], v[20:23]
ds_read_b128 v[180:183], v5 offset:16384
v_mfma_f32_16x16x32_bf16 v[40:43], v[140:143], v[220:223], v[40:43]
s_add_u32 s58, s57, 12288
buffer_load_dwordx4 v[208:211], v10, s[20:23], s58 offen offset:3072 sc1
v_mfma_f32_16x16x32_bf16 v[24:27], v[144:147], v[216:219], v[24:27]
ds_read_b128 v[184:187], v5 offset:17408
v_mfma_f32_16x16x32_bf16 v[44:47], v[144:147], v[220:223], v[44:47]
v_mfma_f32_16x16x32_bf16 v[28:31], v[148:151], v[216:219], v[28:31]
ds_read_b128 v[188:191], v5 offset:18432
v_mfma_f32_16x16x32_bf16 v[48:51], v[148:151], v[220:223], v[48:51]
buffer_load_dwordx4 v[212:215], v11, s[20:23], s58 offen offset:3072 sc1
v_mfma_f32_16x16x32_bf16 v[32:35], v[152:155], v[216:219], v[32:35]
ds_read_b128 v[192:195], v5 offset:19456
v_mfma_f32_16x16x32_bf16 v[52:55], v[152:155], v[220:223], v[52:55]
s_waitcnt vmcnt(10) lgkmcnt(5)
v_mfma_f32_16x16x32_bf16 v[16:19], v[156:159], v[224:227], v[16:19]
ds_read_b128 v[136:139], v5 offset:25600
v_mfma_f32_16x16x32_bf16 v[36:39], v[156:159], v[228:231], v[36:39]
v_mfma_f32_16x16x32_bf16 v[20:23], v[160:163], v[224:227], v[20:23]
ds_read_b128 v[140:143], v5 offset:26624
v_mfma_f32_16x16x32_bf16 v[40:43], v[160:163], v[228:231], v[40:43]
s_add_u32 s58, s57, 16384
buffer_load_dwordx4 v[216:219], v10, s[20:23], s58 offen offset:0 sc1
v_mfma_f32_16x16x32_bf16 v[24:27], v[164:167], v[224:227], v[24:27]
ds_read_b128 v[144:147], v5 offset:27648
v_mfma_f32_16x16x32_bf16 v[44:47], v[164:167], v[228:231], v[44:47]
v_mfma_f32_16x16x32_bf16 v[28:31], v[168:171], v[224:227], v[28:31]
ds_read_b128 v[148:151], v5 offset:28672
v_mfma_f32_16x16x32_bf16 v[48:51], v[168:171], v[228:231], v[48:51]
buffer_load_dwordx4 v[220:223], v11, s[20:23], s58 offen offset:0 sc1
v_mfma_f32_16x16x32_bf16 v[32:35], v[172:175], v[224:227], v[32:35]
ds_read_b128 v[152:155], v5 offset:29696
v_mfma_f32_16x16x32_bf16 v[52:55], v[172:175], v[228:231], v[52:55]
s_waitcnt vmcnt(10) lgkmcnt(5)
v_mfma_f32_16x16x32_bf16 v[16:19], v[176:179], v[232:235], v[16:19]
ds_read_b128 v[156:159], v6 offset:31744
v_mfma_f32_16x16x32_bf16 v[36:39], v[176:179], v[236:239], v[36:39]
v_mfma_f32_16x16x32_bf16 v[20:23], v[180:183], v[232:235], v[20:23]
ds_read_b128 v[160:163], v6 offset:32768
v_mfma_f32_16x16x32_bf16 v[40:43], v[180:183], v[236:239], v[40:43]
s_add_u32 s58, s57, 16384
buffer_load_dwordx4 v[224:227], v10, s[20:23], s58 offen offset:1024 sc1
v_mfma_f32_16x16x32_bf16 v[24:27], v[184:187], v[232:235], v[24:27]
ds_read_b128 v[164:167], v6 offset:33792
v_mfma_f32_16x16x32_bf16 v[44:47], v[184:187], v[236:239], v[44:47]
v_mfma_f32_16x16x32_bf16 v[28:31], v[188:191], v[232:235], v[28:31]
ds_read_b128 v[168:171], v6 offset:34816
v_mfma_f32_16x16x32_bf16 v[48:51], v[188:191], v[236:239], v[48:51]
buffer_load_dwordx4 v[228:231], v11, s[20:23], s58 offen offset:1024 sc1
v_mfma_f32_16x16x32_bf16 v[32:35], v[192:195], v[232:235], v[32:35]
ds_read_b128 v[172:175], v6 offset:35840
v_mfma_f32_16x16x32_bf16 v[52:55], v[192:195], v[236:239], v[52:55]
s_waitcnt vmcnt(10) lgkmcnt(5)
v_mfma_f32_16x16x32_bf16 v[16:19], v[136:139], v[240:243], v[16:19]
ds_read_b128 v[176:179], v7 offset:22528
v_mfma_f32_16x16x32_bf16 v[36:39], v[136:139], v[244:247], v[36:39]
v_mfma_f32_16x16x32_bf16 v[20:23], v[140:143], v[240:243], v[20:23]
ds_read_b128 v[180:183], v7 offset:23552
v_mfma_f32_16x16x32_bf16 v[40:43], v[140:143], v[244:247], v[40:43]
s_add_u32 s58, s57, 16384
buffer_load_dwordx4 v[232:235], v10, s[20:23], s58 offen offset:2048 sc1
v_mfma_f32_16x16x32_bf16 v[24:27], v[144:147], v[240:243], v[24:27]
ds_read_b128 v[184:187], v7 offset:24576
v_mfma_f32_16x16x32_bf16 v[44:47], v[144:147], v[244:247], v[44:47]
v_mfma_f32_16x16x32_bf16 v[28:31], v[148:151], v[240:243], v[28:31]
ds_read_b128 v[188:191], v7 offset:25600
v_mfma_f32_16x16x32_bf16 v[48:51], v[148:151], v[244:247], v[48:51]
buffer_load_dwordx4 v[236:239], v11, s[20:23], s58 offen offset:2048 sc1
v_mfma_f32_16x16x32_bf16 v[32:35], v[152:155], v[240:243], v[32:35]
ds_read_b128 v[192:195], v7 offset:26624
v_mfma_f32_16x16x32_bf16 v[52:55], v[152:155], v[244:247], v[52:55]
s_waitcnt vmcnt(10) lgkmcnt(5)
v_mfma_f32_16x16x32_bf16 v[16:19], v[156:159], v[248:251], v[16:19]
ds_read_b128 v[136:139], v5 offset:40960
v_mfma_f32_16x16x32_bf16 v[36:39], v[156:159], v[252:255], v[36:39]
v_mfma_f32_16x16x32_bf16 v[20:23], v[160:163], v[248:251], v[20:23]
ds_read_b128 v[140:143], v5 offset:41984
v_mfma_f32_16x16x32_bf16 v[40:43], v[160:163], v[252:255], v[40:43]
s_add_u32 s58, s57, 16384
buffer_load_dwordx4 v[240:243], v10, s[20:23], s58 offen offset:3072 sc1
v_mfma_f32_16x16x32_bf16 v[24:27], v[164:167], v[248:251], v[24:27]
ds_read_b128 v[144:147], v5 offset:43008
v_mfma_f32_16x16x32_bf16 v[44:47], v[164:167], v[252:255], v[44:47]
v_mfma_f32_16x16x32_bf16 v[28:31], v[168:171], v[248:251], v[28:31]
ds_read_b128 v[148:151], v5 offset:44032
v_mfma_f32_16x16x32_bf16 v[48:51], v[168:171], v[252:255], v[48:51]
buffer_load_dwordx4 v[244:247], v11, s[20:23], s58 offen offset:3072 sc1
v_mfma_f32_16x16x32_bf16 v[32:35], v[172:175], v[248:251], v[32:35]
ds_read_b128 v[152:155], v5 offset:45056
v_mfma_f32_16x16x32_bf16 v[52:55], v[172:175], v[252:255], v[52:55]
s_waitcnt vmcnt(10) lgkmcnt(5)
s_barrier
v_mfma_f32_16x16x32_bf16 v[16:19], v[176:179], v[200:203], v[16:19]
ds_read_b128 v[156:159], v5 offset:51200
v_mfma_f32_16x16x32_bf16 v[36:39], v[176:179], v[204:207], v[36:39]
v_mfma_f32_16x16x32_bf16 v[20:23], v[180:183], v[200:203], v[20:23]
ds_read_b128 v[160:163], v5 offset:52224
v_mfma_f32_16x16x32_bf16 v[40:43], v[180:183], v[204:207], v[40:43]
s_add_u32 s58, s57, 20480
buffer_load_dwordx4 v[248:251], v10, s[20:23], s58 offen offset:0 sc1
v_mfma_f32_16x16x32_bf16 v[24:27], v[184:187], v[200:203], v[24:27]
ds_read_b128 v[164:167], v5 offset:53248
v_mfma_f32_16x16x32_bf16 v[44:47], v[184:187], v[204:207], v[44:47]
v_mfma_f32_16x16x32_bf16 v[28:31], v[188:191], v[200:203], v[28:31]
ds_read_b128 v[168:171], v5 offset:54272
v_mfma_f32_16x16x32_bf16 v[48:51], v[188:191], v[204:207], v[48:51]
buffer_load_dwordx4 v[252:255], v11, s[20:23], s58 offen offset:0 sc1
v_mfma_f32_16x16x32_bf16 v[32:35], v[192:195], v[200:203], v[32:35]
ds_read_b128 v[172:175], v5 offset:55296
v_mfma_f32_16x16x32_bf16 v[52:55], v[192:195], v[204:207], v[52:55]
s_waitcnt vmcnt(10) lgkmcnt(5)
v_mfma_f32_16x16x32_bf16 v[16:19], v[136:139], v[208:211], v[16:19]
ds_read_b128 v[176:179], v6 offset:52224
v_mfma_f32_16x16x32_bf16 v[36:39], v[136:139], v[212:215], v[36:39]
v_mfma_f32_16x16x32_bf16 v[20:23], v[140:143], v[208:211], v[20:23]
ds_read_b128 v[180:183], v6 offset:53248
v_mfma_f32_16x16x32_bf16 v[40:43], v[140:143], v[212:215], v[40:43]
s_add_u32 s58, s57, 20480
buffer_load_dwordx4 v[200:203], v10, s[20:23], s58 offen offset:1024 sc1
v_mfma_f32_16x16x32_bf16 v[24:27], v[144:147], v[208:211], v[24:27]
ds_read_b128 v[184:187], v6 offset:54272
v_mfma_f32_16x16x32_bf16 v[44:47], v[144:147], v[212:215], v[44:47]
v_mfma_f32_16x16x32_bf16 v[28:31], v[148:151], v[208:211], v[28:31]
ds_read_b128 v[188:191], v6 offset:55296
v_mfma_f32_16x16x32_bf16 v[48:51], v[148:151], v[212:215], v[48:51]
buffer_load_dwordx4 v[204:207], v11, s[20:23], s58 offen offset:1024 sc1
v_mfma_f32_16x16x32_bf16 v[32:35], v[152:155], v[208:211], v[32:35]
ds_read_b128 v[192:195], v6 offset:56320
v_mfma_f32_16x16x32_bf16 v[52:55], v[152:155], v[212:215], v[52:55]
s_waitcnt vmcnt(10) lgkmcnt(5)
v_mfma_f32_16x16x32_bf16 v[16:19], v[156:159], v[216:219], v[16:19]
ds_read_b128 v[136:139], v5 offset:61440
v_mfma_f32_16x16x32_bf16 v[36:39], v[156:159], v[220:223], v[36:39]
v_mfma_f32_16x16x32_bf16 v[20:23], v[160:163], v[216:219], v[20:23]
ds_read_b128 v[140:143], v5 offset:62464
v_mfma_f32_16x16x32_bf16 v[40:43], v[160:163], v[220:223], v[40:43]
s_add_u32 s58, s57, 20480
buffer_load_dwordx4 v[208:211], v10, s[20:23], s58 offen offset:2048 sc1
v_mfma_f32_16x16x32_bf16 v[24:27], v[164:167], v[216:219], v[24:27]
ds_read_b128 v[144:147], v5 offset:63488
v_mfma_f32_16x16x32_bf16 v[44:47], v[164:167], v[220:223], v[44:47]
v_mfma_f32_16x16x32_bf16 v[28:31], v[168:171], v[216:219], v[28:31]
ds_read_b128 v[148:151], v5 offset:64512
v_mfma_f32_16x16x32_bf16 v[48:51], v[168:171], v[220:223], v[48:51]
buffer_load_dwordx4 v[212:215], v11, s[20:23], s58 offen offset:2048 sc1
v_mfma_f32_16x16x32_bf16 v[32:35], v[172:175], v[216:219], v[32:35]
ds_read_b128 v[152:155], v6 offset:0
v_mfma_f32_16x16x32_bf16 v[52:55], v[172:175], v[220:223], v[52:55]
s_waitcnt vmcnt(10) lgkmcnt(5)
v_mfma_f32_16x16x32_bf16 v[16:19], v[176:179], v[224:227], v[16:19]
ds_read_b128 v[156:159], v6 offset:6144
v_mfma_f32_16x16x32_bf16 v[36:39], v[176:179], v[228:231], v[36:39]
v_mfma_f32_16x16x32_bf16 v[20:23], v[180:183], v[224:227], v[20:23]
ds_read_b128 v[160:163], v6 offset:7168
v_mfma_f32_16x16x32_bf16 v[40:43], v[180:183], v[228:231], v[40:43]
s_add_u32 s58, s57, 20480
buffer_load_dwordx4 v[216:219], v10, s[20:23], s58 offen offset:3072 sc1
v_mfma_f32_16x16x32_bf16 v[24:27], v[184:187], v[224:227], v[24:27]
ds_read_b128 v[164:167], v6 offset:8192
v_mfma_f32_16x16x32_bf16 v[44:47], v[184:187], v[228:231], v[44:47]
v_mfma_f32_16x16x32_bf16 v[28:31], v[188:191], v[224:227], v[28:31]
ds_read_b128 v[168:171], v6 offset:9216
v_mfma_f32_16x16x32_bf16 v[48:51], v[188:191], v[228:231], v[48:51]
buffer_load_dwordx4 v[220:223], v11, s[20:23], s58 offen offset:3072 sc1
v_mfma_f32_16x16x32_bf16 v[32:35], v[192:195], v[224:227], v[32:35]
ds_read_b128 v[172:175], v6 offset:10240
v_mfma_f32_16x16x32_bf16 v[52:55], v[192:195], v[228:231], v[52:55]
s_waitcnt vmcnt(10) lgkmcnt(5)
v_mfma_f32_16x16x32_bf16 v[16:19], v[136:139], v[232:235], v[16:19]
ds_read_b128 v[176:179], v6 offset:16384
v_mfma_f32_16x16x32_bf16 v[36:39], v[136:139], v[236:239], v[36:39]
v_mfma_f32_16x16x32_bf16 v[20:23], v[140:143], v[232:235], v[20:23]
ds_read_b128 v[180:183], v6 offset:17408
v_mfma_f32_16x16x32_bf16 v[40:43], v[140:143], v[236:239], v[40:43]
s_add_u32 s58, s57, 24576
buffer_load_dwordx4 v[224:227], v10, s[20:23], s58 offen offset:0 sc1
v_mfma_f32_16x16x32_bf16 v[24:27], v[144:147], v[232:235], v[24:27]
ds_read_b128 v[184:187], v6 offset:18432
v_mfma_f32_16x16x32_bf16 v[44:47], v[144:147], v[236:239], v[44:47]
v_mfma_f32_16x16x32_bf16 v[28:31], v[148:151], v[232:235], v[28:31]
ds_read_b128 v[188:191], v6 offset:19456
v_mfma_f32_16x16x32_bf16 v[48:51], v[148:151], v[236:239], v[48:51]
buffer_load_dwordx4 v[228:231], v11, s[20:23], s58 offen offset:0 sc1
v_mfma_f32_16x16x32_bf16 v[32:35], v[152:155], v[232:235], v[32:35]
ds_read_b128 v[192:195], v6 offset:20480
v_mfma_f32_16x16x32_bf16 v[52:55], v[152:155], v[236:239], v[52:55]
s_waitcnt vmcnt(10) lgkmcnt(5)
v_mfma_f32_16x16x32_bf16 v[16:19], v[156:159], v[240:243], v[16:19]
ds_read_b128 v[136:139], v6 offset:26624
v_mfma_f32_16x16x32_bf16 v[36:39], v[156:159], v[244:247], v[36:39]
v_mfma_f32_16x16x32_bf16 v[20:23], v[160:163], v[240:243], v[20:23]
ds_read_b128 v[140:143], v6 offset:27648
v_mfma_f32_16x16x32_bf16 v[40:43], v[160:163], v[244:247], v[40:43]
s_add_u32 s58, s57, 24576
buffer_load_dwordx4 v[232:235], v10, s[20:23], s58 offen offset:1024 sc1
v_mfma_f32_16x16x32_bf16 v[24:27], v[164:167], v[240:243], v[24:27]
ds_read_b128 v[144:147], v6 offset:28672
v_mfma_f32_16x16x32_bf16 v[44:47], v[164:167], v[244:247], v[44:47]
v_mfma_f32_16x16x32_bf16 v[28:31], v[168:171], v[240:243], v[28:31]
ds_read_b128 v[148:151], v6 offset:29696
v_mfma_f32_16x16x32_bf16 v[48:51], v[168:171], v[244:247], v[48:51]
buffer_load_dwordx4 v[236:239], v11, s[20:23], s58 offen offset:1024 sc1
v_mfma_f32_16x16x32_bf16 v[32:35], v[172:175], v[240:243], v[32:35]
ds_read_b128 v[152:155], v6 offset:30720
v_mfma_f32_16x16x32_bf16 v[52:55], v[172:175], v[244:247], v[52:55]
s_waitcnt vmcnt(10) lgkmcnt(5)
s_barrier
v_mfma_f32_16x16x32_bf16 v[16:19], v[176:179], v[248:251], v[16:19]
ds_read_b128 v[156:159], v7 offset:2048
v_mfma_f32_16x16x32_bf16 v[36:39], v[176:179], v[252:255], v[36:39]
v_mfma_f32_16x16x32_bf16 v[20:23], v[180:183], v[248:251], v[20:23]
ds_read_b128 v[160:163], v7 offset:3072
v_mfma_f32_16x16x32_bf16 v[40:43], v[180:183], v[252:255], v[40:43]
s_add_u32 s58, s57, 24576
buffer_load_dwordx4 v[240:243], v10, s[20:23], s58 offen offset:2048 sc1
v_mfma_f32_16x16x32_bf16 v[24:27], v[184:187], v[248:251], v[24:27]
ds_read_b128 v[164:167], v7 offset:4096
v_mfma_f32_16x16x32_bf16 v[44:47], v[184:187], v[252:255], v[44:47]
v_mfma_f32_16x16x32_bf16 v[28:31], v[188:191], v[248:251], v[28:31]
ds_read_b128 v[168:171], v7 offset:5120
v_mfma_f32_16x16x32_bf16 v[48:51], v[188:191], v[252:255], v[48:51]
buffer_load_dwordx4 v[244:247], v11, s[20:23], s58 offen offset:2048 sc1
v_mfma_f32_16x16x32_bf16 v[32:35], v[192:195], v[248:251], v[32:35]
ds_read_b128 v[172:175], v7 offset:6144
v_mfma_f32_16x16x32_bf16 v[52:55], v[192:195], v[252:255], v[52:55]
s_waitcnt vmcnt(10) lgkmcnt(5)
v_mfma_f32_16x16x32_bf16 v[16:19], v[136:139], v[200:203], v[16:19]
ds_read_b128 v[176:179], v7 offset:12288
v_mfma_f32_16x16x32_bf16 v[36:39], v[136:139], v[204:207], v[36:39]
v_mfma_f32_16x16x32_bf16 v[20:23], v[140:143], v[200:203], v[20:23]
ds_read_b128 v[180:183], v7 offset:13312
v_mfma_f32_16x16x32_bf16 v[40:43], v[140:143], v[204:207], v[40:43]
v_mfma_f32_16x16x32_bf16 v[24:27], v[144:147], v[200:203], v[24:27]
ds_read_b128 v[184:187], v7 offset:14336
v_mfma_f32_16x16x32_bf16 v[44:47], v[144:147], v[204:207], v[44:47]
v_mfma_f32_16x16x32_bf16 v[28:31], v[148:151], v[200:203], v[28:31]
ds_read_b128 v[188:191], v7 offset:15360
v_mfma_f32_16x16x32_bf16 v[48:51], v[148:151], v[204:207], v[48:51]
v_mfma_f32_16x16x32_bf16 v[32:35], v[152:155], v[200:203], v[32:35]
ds_read_b128 v[192:195], v7 offset:16384
v_mfma_f32_16x16x32_bf16 v[52:55], v[152:155], v[204:207], v[52:55]
s_waitcnt vmcnt(8) lgkmcnt(5)
v_mfma_f32_16x16x32_bf16 v[16:19], v[156:159], v[208:211], v[16:19]
ds_read_b128 v[136:139], v5 offset:5120
v_mfma_f32_16x16x32_bf16 v[36:39], v[156:159], v[212:215], v[36:39]
v_mfma_f32_16x16x32_bf16 v[20:23], v[160:163], v[208:211], v[20:23]
ds_read_b128 v[140:143], v5 offset:6144
v_mfma_f32_16x16x32_bf16 v[40:43], v[160:163], v[212:215], v[40:43]
v_mfma_f32_16x16x32_bf16 v[24:27], v[164:167], v[208:211], v[24:27]
ds_read_b128 v[144:147], v5 offset:7168
v_mfma_f32_16x16x32_bf16 v[44:47], v[164:167], v[212:215], v[44:47]
v_mfma_f32_16x16x32_bf16 v[28:31], v[168:171], v[208:211], v[28:31]
ds_read_b128 v[148:151], v5 offset:8192
v_mfma_f32_16x16x32_bf16 v[48:51], v[168:171], v[212:215], v[48:51]
v_mfma_f32_16x16x32_bf16 v[32:35], v[172:175], v[208:211], v[32:35]
ds_read_b128 v[152:155], v5 offset:9216
v_mfma_f32_16x16x32_bf16 v[52:55], v[172:175], v[212:215], v[52:55]
s_waitcnt vmcnt(6) lgkmcnt(5)
v_mfma_f32_16x16x32_bf16 v[16:19], v[176:179], v[216:219], v[16:19]
ds_read_b128 v[156:159], v5 offset:15360
v_mfma_f32_16x16x32_bf16 v[36:39], v[176:179], v[220:223], v[36:39]
v_mfma_f32_16x16x32_bf16 v[20:23], v[180:183], v[216:219], v[20:23]
ds_read_b128 v[160:163], v5 offset:16384
v_mfma_f32_16x16x32_bf16 v[40:43], v[180:183], v[220:223], v[40:43]
v_mfma_f32_16x16x32_bf16 v[24:27], v[184:187], v[216:219], v[24:27]
ds_read_b128 v[164:167], v5 offset:17408
v_mfma_f32_16x16x32_bf16 v[44:47], v[184:187], v[220:223], v[44:47]
v_mfma_f32_16x16x32_bf16 v[28:31], v[188:191], v[216:219], v[28:31]
ds_read_b128 v[168:171], v5 offset:18432
v_mfma_f32_16x16x32_bf16 v[48:51], v[188:191], v[220:223], v[48:51]
v_mfma_f32_16x16x32_bf16 v[32:35], v[192:195], v[216:219], v[32:35]
ds_read_b128 v[172:175], v5 offset:19456
v_mfma_f32_16x16x32_bf16 v[52:55], v[192:195], v[220:223], v[52:55]
s_waitcnt vmcnt(4) lgkmcnt(5)
v_mfma_f32_16x16x32_bf16 v[16:19], v[136:139], v[224:227], v[16:19]
ds_read_b128 v[176:179], v6 offset:41984
v_mfma_f32_16x16x32_bf16 v[36:39], v[136:139], v[228:231], v[36:39]
v_mfma_f32_16x16x32_bf16 v[20:23], v[140:143], v[224:227], v[20:23]
ds_read_b128 v[180:183], v6 offset:43008
v_mfma_f32_16x16x32_bf16 v[40:43], v[140:143], v[228:231], v[40:43]
v_mfma_f32_16x16x32_bf16 v[24:27], v[144:147], v[224:227], v[24:27]
ds_read_b128 v[184:187], v6 offset:44032
v_mfma_f32_16x16x32_bf16 v[44:47], v[144:147], v[228:231], v[44:47]
v_mfma_f32_16x16x32_bf16 v[28:31], v[148:151], v[224:227], v[28:31]
ds_read_b128 v[188:191], v6 offset:45056
v_mfma_f32_16x16x32_bf16 v[48:51], v[148:151], v[228:231], v[48:51]
v_mfma_f32_16x16x32_bf16 v[32:35], v[152:155], v[224:227], v[32:35]
ds_read_b128 v[192:195], v6 offset:46080
v_mfma_f32_16x16x32_bf16 v[52:55], v[152:155], v[228:231], v[52:55]
s_waitcnt vmcnt(2) lgkmcnt(5)
v_mfma_f32_16x16x32_bf16 v[16:19], v[156:159], v[232:235], v[16:19]
v_mfma_f32_16x16x32_bf16 v[36:39], v[156:159], v[236:239], v[36:39]
v_mfma_f32_16x16x32_bf16 v[20:23], v[160:163], v[232:235], v[20:23]
v_mfma_f32_16x16x32_bf16 v[40:43], v[160:163], v[236:239], v[40:43]
v_mfma_f32_16x16x32_bf16 v[24:27], v[164:167], v[232:235], v[24:27]
v_mfma_f32_16x16x32_bf16 v[44:47], v[164:167], v[236:239], v[44:47]
v_mfma_f32_16x16x32_bf16 v[28:31], v[168:171], v[232:235], v[28:31]
v_mfma_f32_16x16x32_bf16 v[48:51], v[168:171], v[236:239], v[48:51]
v_mfma_f32_16x16x32_bf16 v[32:35], v[172:175], v[232:235], v[32:35]
v_mfma_f32_16x16x32_bf16 v[52:55], v[172:175], v[236:239], v[52:55]
s_waitcnt vmcnt(0) lgkmcnt(0)
v_mfma_f32_16x16x32_bf16 v[16:19], v[176:179], v[240:243], v[16:19]
v_mfma_f32_16x16x32_bf16 v[36:39], v[176:179], v[244:247], v[36:39]
v_mfma_f32_16x16x32_bf16 v[20:23], v[180:183], v[240:243], v[20:23]
v_mfma_f32_16x16x32_bf16 v[40:43], v[180:183], v[244:247], v[40:43]
v_mfma_f32_16x16x32_bf16 v[24:27], v[184:187], v[240:243], v[24:27]
v_mfma_f32_16x16x32_bf16 v[44:47], v[184:187], v[244:247], v[44:47]
v_mfma_f32_16x16x32_bf16 v[28:31], v[188:191], v[240:243], v[28:31]
v_mfma_f32_16x16x32_bf16 v[48:51], v[188:191], v[244:247], v[48:51]
v_mfma_f32_16x16x32_bf16 v[32:35], v[192:195], v[240:243], v[32:35]
v_mfma_f32_16x16x32_bf16 v[52:55], v[192:195], v[244:247], v[52:55]
s_mov_b32 s59, 20480
s_cmp_eq_u32 s55, 1
s_cselect_b32 s59, 30720, s59
v_add_u32 v4, s59, v10
s_mov_b32 s59, 25600
s_cmp_eq_u32 s55, 1
s_cselect_b32 s59, 97280, s59
v_add_u32 v15, s59, v10
s_nop 1
ds_write_b128 v4, v[16:19] offset:0
ds_write_b128 v4, v[20:23] offset:1024
ds_write_b128 v4, v[24:27] offset:2048
ds_write_b128 v4, v[28:31] offset:3072
ds_write_b128 v4, v[32:35] offset:4096
v_and_b32 v4, 15, v0
v_mul_u32_u24 v4, 1280, v4
v_lshrrev_b32 v6, 4, v0
v_lshrrev_b32 v7, 1, v6
v_lshlrev_b32 v7, 4, v7
v_and_b32 v5, 1, v6
v_lshlrev_b32 v5, 5, v5
v_add_u32 v7, v7, v5
v_add_u32 v7, v4, v7
v_lshlrev_b32 v6, 3, v6
v_add_u32 v4, v4, v6
s_lshl_b32 s57, s50, 6
s_lshl_b32 s58, s55, 5
s_add_u32 s57, s57, s58
s_add_u32 s57, s57, 16
s_mul_i32 s57, s57, 1280
s_mul_i32 s58, s51, 160
s_add_u32 s57, s57, s58
s_waitcnt lgkmcnt(0)
s_barrier
ds_read_b128 v[64:67], v15 offset:0
ds_read_b128 v[68:71], v15 offset:1024
ds_read_b128 v[72:75], v15 offset:2048
ds_read_b128 v[76:79], v15 offset:3072
ds_read_b128 v[80:83], v15 offset:4096
s_waitcnt lgkmcnt(4)
v_pk_add_f32 v[36:37], v[36:37], v[64:65]
v_pk_add_f32 v[38:39], v[38:39], v[66:67]
v_cvt_pk_bf16_f32 v96, v36, v37
v_cvt_pk_bf16_f32 v97, v38, v39
s_waitcnt lgkmcnt(3)
v_pk_add_f32 v[40:41], v[40:41], v[68:69]
v_pk_add_f32 v[42:43], v[42:43], v[70:71]
v_cvt_pk_bf16_f32 v98, v40, v41
v_cvt_pk_bf16_f32 v99, v42, v43
s_nop 1
v_permlane16_swap_b32 v96, v98
v_permlane16_swap_b32 v97, v99
buffer_store_dwordx4 v[96:99], v7, s[28:31], s57 offen offset:0
s_waitcnt lgkmcnt(2)
v_pk_add_f32 v[44:45], v[44:45], v[72:73]
v_pk_add_f32 v[46:47], v[46:47], v[74:75]
v_cvt_pk_bf16_f32 v100, v44, v45
v_cvt_pk_bf16_f32 v101, v46, v47
s_waitcnt lgkmcnt(1)
v_pk_add_f32 v[48:49], v[48:49], v[76:77]
v_pk_add_f32 v[50:51], v[50:51], v[78:79]
v_cvt_pk_bf16_f32 v102, v48, v49
v_cvt_pk_bf16_f32 v103, v50, v51
s_nop 1
v_permlane16_swap_b32 v100, v102
v_permlane16_swap_b32 v101, v103
buffer_store_dwordx4 v[100:103], v7, s[28:31], s57 offen offset:64
s_waitcnt lgkmcnt(0)
v_pk_add_f32 v[52:53], v[52:53], v[80:81]
v_pk_add_f32 v[54:55], v[54:55], v[82:83]
v_cvt_pk_bf16_f32 v104, v52, v53
v_cvt_pk_bf16_f32 v105, v54, v55
buffer_store_dwordx2 v[104:105], v4, s[28:31], s57 offen offset:128
s_endpgm
standalone__swiglu_ffn__prompt_kernel_pf_entry:
s_sub_u32 s61, s47, 28
s_lshl_b32 s61, s61, 3
s_add_u32 s61, s61, s46
s_sub_u32 s60, s47, 24
s_lshl_b32 s60, s60, 1
s_add_u32 s60, s60, s46
s_add_u32 s60, s60, 26
s_cmp_ge_u32 s47, 28
s_cselect_b32 s69, s61, s60
v_mov_b32 v23, 0x7f000000
s_mul_i32 s61, s69, 52
v_add_u32 v20, s61, v0
v_mul_u32_u24 v21, 1280, v20
v_cmp_gt_u32 vcc, 52, v0
s_nop 1
v_cndmask_b32 v21, v23, v21, vcc
s_mul_i32 s61, s69, 44
v_add_u32 v20, s61, v0
v_mul_u32_u24 v22, 2428, v20
v_lshrrev_b32 v22, 16, v22
v_mul_u32_u24 v24, 27, v22
v_sub_u32 v24, v20, v24
v_lshlrev_b32 v24, 7, v24
v_mul_u32_u24 v22, 3456, v22
v_add_u32 v22, v22, v24
v_cmp_gt_u32 vcc, 44, v0
s_nop 1
v_cndmask_b32 v22, v23, v22, vcc
v_cmp_gt_u32 vcc, 1728, v20
s_nop 1
v_cndmask_b32 v22, v23, v22, vcc
s_cmp_eq_u32 s3, 0
s_cselect_b64 vcc, -1, 0
s_nop 1
v_cndmask_b32 v22, v22, v21, vcc
s_cmp_eq_u32 s3, 0
s_mov_b32 s66, 221184
s_cselect_b32 s66, 128, s66
s_mul_i32 s67, s66, 1
s_waitcnt lgkmcnt(0)
s_cmp_eq_u32 s3, 0
s_cselect_b32 s32, s4, s6
s_cselect_b32 s33, s5, s7
s_mov_b32 s34, 2211840
s_cselect_b32 s34, 2621440, s34
s_cmp_eq_u32 s3, 2
s_cselect_b32 s32, s36, s32
s_cselect_b32 s33, s37, s33
s_mov_b32 s35, 0x20000
buffer_load_dword v40, v22, s[32:35], s67 offen
s_add_u32 s67, s67, s66
buffer_load_dword v40, v22, s[32:35], s67 offen
s_add_u32 s67, s67, s66
buffer_load_dword v40, v22, s[32:35], s67 offen
s_add_u32 s67, s67, s66
buffer_load_dword v40, v22, s[32:35], s67 offen
s_add_u32 s67, s67, s66
buffer_load_dword v40, v22, s[32:35], s67 offen
s_add_u32 s67, s67, s66
buffer_load_dword v40, v22, s[32:35], s67 offen
s_add_u32 s67, s67, s66
buffer_load_dword v40, v22, s[32:35], s67 offen
s_add_u32 s67, s67, s66
buffer_load_dword v40, v22, s[32:35], s67 offen
s_add_u32 s67, s67, s66
buffer_load_dword v40, v22, s[32:35], s67 offen
s_add_u32 s67, s67, s66
s_lshr_b32 s55, s3, 1
s_and_b32 s56, s3, 1
v_and_b32 v16, 31, v0
v_lshlrev_b32 v16, 2, v16
s_mov_b32 s20, s44
s_mov_b32 s21, s45
s_mov_b32 s22, 7077888
s_mov_b32 s23, 0x20000
s_mov_b32 s28, s40
s_mov_b32 s29, s41
s_mov_b32 s30, 2621440
s_mov_b32 s31, 0x20000
s_lshl_b32 s61, s2, 7
s_add_u32 s61, s61, 12582912
s_add_u32 s62, s44, s61
s_addc_u32 s63, s45, 0
s_barrier
s_branch standalone__swiglu_ffn__prompt_kernel_sp_j
standalone__swiglu_ffn__prompt_kernel_spare_cw:
s_waitcnt lgkmcnt(0)
s_barrier
s_waitcnt vmcnt(0)
s_and_b32 s61, s2, 1
s_lshl_b32 s61, s61, 7
s_add_u32 s61, s61, 64
v_mov_b32 v20, s61
v_mov_b32 v21, 1
s_mov_b64 exec, 1
global_atomic_add v20, v21, s[42:43] sc1
s_mov_b64 exec, -1
standalone__swiglu_ffn__prompt_kernel_sp_j:
s_barrier
s_cmp_lg_u32 s2, 223
s_cbranch_scc1 standalone__swiglu_ffn__prompt_kernel_sp_x
s_cmp_lg_u32 s3, 3
s_cbranch_scc1 standalone__swiglu_ffn__prompt_kernel_sp_x
v_mov_b32 v23, 0
v_mov_b32 v24, 64
v_mov_b32 v27, 192
s_mov_b32 s65, 400000
standalone__swiglu_ffn__prompt_kernel_mst_poll:
global_load_dword v25, v23, s[42:43] sc1
global_load_dword v26, v24, s[42:43] sc1
global_load_dword v28, v27, s[42:43] sc1
s_waitcnt vmcnt(0)
v_readfirstlane_b32 s64, v25
v_readfirstlane_b32 s61, v26
v_readfirstlane_b32 s58, v28
s_min_u32 s61, s61, s58
s_cmp_ge_u32 s64, 36
s_cselect_b32 s61, s61, 0
s_cmp_ge_u32 s61, 128
s_cbranch_scc1 standalone__swiglu_ffn__prompt_kernel_mst_done
s_sub_u32 s65, s65, 1
s_cmp_lg_u32 s65, 0
s_cbranch_scc1 standalone__swiglu_ffn__prompt_kernel_mst_poll
standalone__swiglu_ffn__prompt_kernel_mst_done:
v_lshlrev_b32 v23, 7, v0
v_add_u32 v23, 12583024, v23
v_mov_b32 v24, 1
global_store_dword v23, v24, s[44:45] sc1
v_add_u32 v23, 8192, v23
global_store_dword v23, v24, s[44:45] sc1
v_add_u32 v23, 8192, v23
global_store_dword v23, v24, s[44:45] sc1
v_add_u32 v23, 8192, v23
global_store_dword v23, v24, s[44:45] sc1
standalone__swiglu_ffn__prompt_kernel_sp_x:
s_barrier
v_lshrrev_b32 v12, 2, v0
v_mul_u32_u24 v12, 160, v12
v_and_b32 v13, 3, v0
v_lshlrev_b32 v13, 3, v13
v_add_u32 v12, v12, v13
v_add_u32 v13, 0x10000, v12
v_add_u32 v14, 0x20000, v12
v_mov_b32 v5, v10
v_add_u32 v6, 0x10000, v10
v_add_u32 v7, 0x20000, v10
s_lshl_b32 s57, s50, 2
s_lshl_b32 s58, s55, 1
s_add_u32 s57, s57, s58
s_mul_i32 s57, s57, 54
s_mul_i32 s58, s56, 27
s_add_u32 s57, s57, s58
s_lshl_b32 s57, s57, 10
v_add_u32 v11, 55296, v10
s_cmp_eq_u32 s56, 1
s_cbranch_scc1 standalone__swiglu_ffn__prompt_kernel_pre1s
ds_read_b64_tr_b16 v[56:57], v14 offset:17408
ds_read_b64_tr_b16 v[58:59], v14 offset:19968
ds_read_b64_tr_b16 v[60:61], v14 offset:17440
ds_read_b64_tr_b16 v[62:63], v14 offset:20000
ds_read_b64_tr_b16 v[64:65], v14 offset:17472
ds_read_b64_tr_b16 v[66:67], v14 offset:20032
ds_read_b64_tr_b16 v[68:69], v14 offset:17504
ds_read_b64_tr_b16 v[70:71], v14 offset:20064
ds_read_b64_tr_b16 v[72:73], v14 offset:17536
ds_read_b64_tr_b16 v[74:75], v14 offset:20096
ds_read_b64_tr_b16 v[76:77], v12 offset:35840
ds_read_b64_tr_b16 v[78:79], v12 offset:38400
ds_read_b64_tr_b16 v[80:81], v12 offset:35872
ds_read_b64_tr_b16 v[82:83], v12 offset:38432
ds_read_b64_tr_b16 v[84:85], v12 offset:35904
ds_read_b64_tr_b16 v[86:87], v12 offset:38464
ds_read_b64_tr_b16 v[88:89], v12 offset:35936
ds_read_b64_tr_b16 v[90:91], v12 offset:38496
ds_read_b64_tr_b16 v[92:93], v12 offset:35968
ds_read_b64_tr_b16 v[94:95], v12 offset:38528
ds_read_b64_tr_b16 v[96:97], v12 offset:46080
ds_read_b64_tr_b16 v[98:99], v12 offset:48640
ds_read_b64_tr_b16 v[100:101], v12 offset:46112
ds_read_b64_tr_b16 v[102:103], v12 offset:48672
ds_read_b64_tr_b16 v[104:105], v12 offset:46144
ds_read_b64_tr_b16 v[106:107], v12 offset:48704
ds_read_b64_tr_b16 v[108:109], v12 offset:46176
ds_read_b64_tr_b16 v[110:111], v12 offset:48736
ds_read_b64_tr_b16 v[112:113], v12 offset:46208
ds_read_b64_tr_b16 v[114:115], v12 offset:48768
ds_read_b64_tr_b16 v[116:117], v12 offset:56320
ds_read_b64_tr_b16 v[118:119], v12 offset:58880
ds_read_b64_tr_b16 v[120:121], v12 offset:56352
ds_read_b64_tr_b16 v[122:123], v12 offset:58912
ds_read_b64_tr_b16 v[124:125], v12 offset:56384
ds_read_b64_tr_b16 v[126:127], v12 offset:58944
ds_read_b64_tr_b16 v[128:129], v12 offset:56416
ds_read_b64_tr_b16 v[130:131], v12 offset:58976
ds_read_b64_tr_b16 v[132:133], v12 offset:56448
ds_read_b64_tr_b16 v[134:135], v12 offset:59008
s_branch standalone__swiglu_ffn__prompt_kernel_pre2s
standalone__swiglu_ffn__prompt_kernel_pre1s:
ds_read_b64_tr_b16 v[56:57], v14 offset:22528
ds_read_b64_tr_b16 v[58:59], v14 offset:25088
ds_read_b64_tr_b16 v[60:61], v14 offset:22560
ds_read_b64_tr_b16 v[62:63], v14 offset:25120
ds_read_b64_tr_b16 v[64:65], v14 offset:22592
ds_read_b64_tr_b16 v[66:67], v14 offset:25152
ds_read_b64_tr_b16 v[68:69], v14 offset:22624
ds_read_b64_tr_b16 v[70:71], v14 offset:25184
ds_read_b64_tr_b16 v[72:73], v14 offset:22656
ds_read_b64_tr_b16 v[74:75], v14 offset:25216
ds_read_b64_tr_b16 v[76:77], v12 offset:40960
ds_read_b64_tr_b16 v[78:79], v12 offset:43520
ds_read_b64_tr_b16 v[80:81], v12 offset:40992
ds_read_b64_tr_b16 v[82:83], v12 offset:43552
ds_read_b64_tr_b16 v[84:85], v12 offset:41024
ds_read_b64_tr_b16 v[86:87], v12 offset:43584
ds_read_b64_tr_b16 v[88:89], v12 offset:41056
ds_read_b64_tr_b16 v[90:91], v12 offset:43616
ds_read_b64_tr_b16 v[92:93], v12 offset:41088
ds_read_b64_tr_b16 v[94:95], v12 offset:43648
ds_read_b64_tr_b16 v[96:97], v12 offset:51200
ds_read_b64_tr_b16 v[98:99], v12 offset:53760
ds_read_b64_tr_b16 v[100:101], v12 offset:51232
ds_read_b64_tr_b16 v[102:103], v12 offset:53792
ds_read_b64_tr_b16 v[104:105], v12 offset:51264
ds_read_b64_tr_b16 v[106:107], v12 offset:53824
ds_read_b64_tr_b16 v[108:109], v12 offset:51296
ds_read_b64_tr_b16 v[110:111], v12 offset:53856
ds_read_b64_tr_b16 v[112:113], v12 offset:51328
ds_read_b64_tr_b16 v[114:115], v12 offset:53888
ds_read_b64_tr_b16 v[116:117], v13 offset:52224
ds_read_b64_tr_b16 v[118:119], v13 offset:54784
ds_read_b64_tr_b16 v[120:121], v13 offset:52256
ds_read_b64_tr_b16 v[122:123], v13 offset:54816
ds_read_b64_tr_b16 v[124:125], v13 offset:52288
ds_read_b64_tr_b16 v[126:127], v13 offset:54848
ds_read_b64_tr_b16 v[128:129], v13 offset:52320
ds_read_b64_tr_b16 v[130:131], v13 offset:54880
ds_read_b64_tr_b16 v[132:133], v13 offset:52352
ds_read_b64_tr_b16 v[134:135], v13 offset:54912
standalone__swiglu_ffn__prompt_kernel_pre2s:
s_waitcnt lgkmcnt(0)
v_mov_b32 v1, 163584
v_mov_b32 v2, 1
s_mov_b64 exec, 1
ds_add_u32 v1, v2 offset:16
s_mov_b64 exec, -1
s_branch standalone__swiglu_ffn__prompt_kernel_p2
standalone__swiglu_ffn__prompt_kernel_exit:
s_endpgm
.section .rodata,"a"
.p2align 6
.amdhsa_kernel standalone__swiglu_ffn__prompt_kernel
  .amdhsa_next_free_vgpr 256
  .amdhsa_next_free_sgpr 102
  .amdhsa_accum_offset 256
  .amdhsa_group_segment_fixed_size 0
  .amdhsa_kernarg_size 56
  .amdhsa_user_sgpr_count 2
  .amdhsa_user_sgpr_kernarg_segment_ptr 1
  .amdhsa_system_sgpr_workgroup_id_x 1
.end_amdhsa_kernel
```
